```python
import torch

def _softmax(x, axis=-1):
    return torch.softmax(x, dim=axis)
def _gelu(x):
    return torch.nn.functional.gelu(x, approximate="tanh")
def _silu(x):
    return torch.nn.functional.silu(x)
def _sigmoid(x):
    return torch.sigmoid(x)
def _layernorm(x, axis=-1, eps=1e-5):
    m = x.mean(dim=axis, keepdim=True)
    v = x.var(dim=axis, keepdim=True, unbiased=False)
    return (x - m) / torch.sqrt(v + eps)
def _scatter_add(tgt, idx, src, axis=0):
    return tgt.clone().index_add_(axis, idx, src)
def _segment_sum(src, seg, n):
    out = torch.zeros((n,) + src.shape[1:], dtype=src.dtype)
    return out.index_add_(0, seg, src)
def _pad(x, pw):
    flat = tuple(v for pair in reversed(pw) for v in pair)
    return torch.nn.functional.pad(x, flat)

kernel_name = 'sequential_preLN__mha_block_cached__dense_activation_relu__decode'

def setup_inputs():

    _w = (lambda a: (lambda t: t.to(torch.bfloat16) if t.is_floating_point() else t)(torch.as_tensor(a)))
    def _A_setup():
        B, Sq, D = 1, 1, 640
        H, Sk, Dh = 32, 32768, 192
        return {
            "x": _w((lambda *s: torch.randn(*s, dtype=torch.bfloat16) * 0.05)(B, Sq, D)),
            "k_cache": _w((lambda *s: torch.randn(*s, dtype=torch.bfloat16) * 3.2)(B, H, Sk, Dh)),
            "v_cache": _w((lambda *s: torch.randn(*s, dtype=torch.bfloat16) * 0.4)(B, H, Sk, Dh)),
            "wq": _w((lambda *s: torch.randn(*s, dtype=torch.bfloat16) * 3.2)(D, H * Dh) * (D ** -0.5)),
            "wo": _w((lambda *s: torch.randn(*s, dtype=torch.bfloat16) * 0.4)(H * Dh, D) * ((H * Dh) ** -0.5)),
        }
    _A_in = _A_setup()

    def _B_setup():
        B, S, D, Dff = 1, 1, 640, 1536
        return {
            "x": _w((lambda *s: torch.randn(*s, dtype=torch.bfloat16) * 0.05)(B, S, D)),
            "w1": _w((lambda *s: torch.randn(*s, dtype=torch.bfloat16) * 0.05)(D, Dff)),
            "w2": _w((lambda *s: torch.randn(*s, dtype=torch.bfloat16) * 0.05)(Dff, D)),
        }
    _B_in = _B_setup()

    return {
        "A_x": _A_in["x"],
        "A_k_cache": _A_in["k_cache"],
        "A_v_cache": _A_in["v_cache"],
        "A_wq": _A_in["wq"],
        "A_wo": _A_in["wo"],
        "B_x": _B_in["x"],
        "B_w1": _B_in["w1"],
        "B_w2": _B_in["w2"],
    }

def reference(A_x, A_k_cache, A_v_cache, A_wq, A_wo, B_x, B_w1, B_w2):
    def _A_ref(x, k_cache, v_cache, wq, wo):
        B, Sq, D = x.shape
        H, Dh = 32, 192
        q = (lambda x, *d: x.permute(*d))((x @ wq).reshape(B, Sq, H, Dh), 0, 2, 1, 3)
        scores = torch.einsum("bhqd,bhkd->bhqk", q, k_cache) * (Dh ** -0.5)
        p = _softmax(scores, axis=-1)
        o = torch.einsum("bhqk,bhkd->bhqd", p, v_cache)
        return (lambda x, *d: x.permute(*d))(o, 0, 2, 1, 3).reshape(B, Sq, H * Dh) @ wo

    def _B_ref(x, w1, w2):
        h = torch.einsum("bsd,df->bsf", x, w1)
        zero = torch.zeros_like(h)
        h = torch.maximum(h, zero)
        return torch.einsum("bsf,fd->bsd", h, w2)

    x = A_x
    h = x + _A_ref(_layernorm(x, axis=-1), A_k_cache, A_v_cache, A_wq, A_wo)
    h2 = h + _B_ref(_layernorm(h, axis=-1), B_w1, B_w2)
    return h2
```

```asm
; @launch grid=(256,1,1) block=(320,1,1) lds=143360
.amdgcn_target "amdgcn-amd-amdhsa--gfx950"
.text
.globl sequential_preLN__mha_block_cached__dense_activation_relu__decode_kernel
.p2align 8
.type sequential_preLN__mha_block_cached__dense_activation_relu__decode_kernel,@function
sequential_preLN__mha_block_cached__dense_activation_relu__decode_kernel:
  s_cmp_ge_u32 s2, 256
  s_cbranch_scc1 L_end
  s_load_dwordx16 s[24:39], s[0:1], 0
  s_load_dwordx4 s[40:43], s[0:1], 64
  s_load_dwordx2 s[44:45], s[0:1], 80
  v_lshrrev_b32 v1, 6, v0
  v_and_b32 v0, 63, v0
  v_readfirstlane_b32 s3, v1
  s_lshr_b32 s47, s2, 3
  s_and_b32 s48, s2, 7
  s_lshr_b32 s96, s47, 2
  s_and_b32 s97, s47, 3
  s_lshl_b32 s63, s48, 2
  s_add_u32 s97, s97, s63
  s_and_b32 s63, s47, 3
  s_lshl_b32 s64, s63, 1
  s_add_u32 s64, s64, s96
  s_and_b32 s64, s64, 7
  s_mul_i32 s65, s96, 3
  s_add_u32 s65, s65, s63
  s_add_u32 s65, s65, 80
  s_add_u32 s66, s96, 104
  s_cmp_eq_u32 s63, 3
  s_cselect_b32 s65, s66, s65
  s_cmp_eq_u32 s64, s48
  s_cselect_b32 s49, s65, 255
  s_mov_b32 s55, s65
  s_mov_b32 s49, 255
  s_cmp_lg_u32 s3, 4
  s_cbranch_scc1 L_stream
  v_and_b32 v10, 15, v0
  v_lshrrev_b32 v11, 4, v0
  v_mul_u32_u24 v11, 24576, v11
  v_lshl_add_u32 v1, v10, 4, v11
  v_add_u32 v7, 12416, v1
  v_mov_b32 v2, 256
  v_mov_b32 v11, 12160
  v_cmp_gt_u32 vcc, 8, v10
  s_nop 1
  v_cndmask_b32 v2, v11, v2, vcc
  v_add_u32 v2, v1, v2
  s_mov_b32 s65, s48
  s_mov_b32 s66, s47
  v_lshlrev_b32 v8, 2, v0
  v_lshrrev_b32 v9, 3, v0
  s_mul_i32 s63, s65, 80
  v_add_lshl_u32 v9, v9, s63, 1
  s_mul_i32 s50, s63, 12288
  s_mul_i32 s64, s66, 384
  s_add_u32 s50, s50, s64
  v_mov_b32 v10, 0
  v_and_b32 v11, 124, v8
  ds_write_b32 v11, v10 offset:1536
  s_waitcnt lgkmcnt(0)
  s_load_dword s46, s[44:45], 0
  s_mov_b32 s8, s24
  s_and_b32 s9, s25, 0xffff
  s_mov_b32 s10, 1280
  s_mov_b32 s11, 0x20000
  s_mov_b32 s4, s30
  s_and_b32 s5, s31, 0xffff
  s_mov_b32 s6, 7864320
  s_mov_b32 s7, 0x20000
  buffer_load_dword v24, v8, s[8:11], 0 offen offset:0
  buffer_load_dword v25, v8, s[8:11], 0 offen offset:256
  buffer_load_dword v26, v8, s[8:11], 0 offen offset:512
  buffer_load_dword v27, v8, s[8:11], 0 offen offset:768
  buffer_load_dword v28, v8, s[8:11], 0 offen offset:1024
  buffer_load_ushort v32, v9, s[8:11], 0 offen offset:0
  buffer_load_ushort v33, v9, s[8:11], 0 offen offset:16
  buffer_load_ushort v34, v9, s[8:11], 0 offen offset:32
  buffer_load_ushort v35, v9, s[8:11], 0 offen offset:48
  buffer_load_ushort v36, v9, s[8:11], 0 offen offset:64
  buffer_load_ushort v37, v9, s[8:11], 0 offen offset:80
  buffer_load_ushort v38, v9, s[8:11], 0 offen offset:96
  buffer_load_ushort v39, v9, s[8:11], 0 offen offset:112
  buffer_load_ushort v40, v9, s[8:11], 0 offen offset:128
  buffer_load_ushort v41, v9, s[8:11], 0 offen offset:144
  buffer_load_dwordx4 a[0:3], v1, s[4:7], s50 offen nt
  buffer_load_dwordx4 a[4:7], v2, s[4:7], s50 offen nt
  buffer_load_dwordx4 a[8:11], v7, s[4:7], s50 offen nt
  s_add_u32 s50, s50, 98304
  buffer_load_dwordx4 a[12:15], v1, s[4:7], s50 offen nt
  buffer_load_dwordx4 a[16:19], v2, s[4:7], s50 offen nt
  buffer_load_dwordx4 a[20:23], v7, s[4:7], s50 offen nt
  s_add_u32 s50, s50, 98304
  buffer_load_dwordx4 a[24:27], v1, s[4:7], s50 offen nt
  buffer_load_dwordx4 a[28:31], v2, s[4:7], s50 offen nt
  buffer_load_dwordx4 a[32:35], v7, s[4:7], s50 offen nt
  s_add_u32 s50, s50, 98304
  buffer_load_dwordx4 a[36:39], v1, s[4:7], s50 offen nt
  buffer_load_dwordx4 a[40:43], v2, s[4:7], s50 offen nt
  buffer_load_dwordx4 a[44:47], v7, s[4:7], s50 offen nt
  s_add_u32 s50, s50, 98304
  buffer_load_dwordx4 a[48:51], v1, s[4:7], s50 offen nt
  buffer_load_dwordx4 a[52:55], v2, s[4:7], s50 offen nt
  buffer_load_dwordx4 a[56:59], v7, s[4:7], s50 offen nt
  s_add_u32 s50, s50, 98304
  buffer_load_dwordx4 a[60:63], v1, s[4:7], s50 offen nt
  buffer_load_dwordx4 a[64:67], v2, s[4:7], s50 offen nt
  buffer_load_dwordx4 a[68:71], v7, s[4:7], s50 offen nt
  s_add_u32 s50, s50, 98304
  buffer_load_dwordx4 a[72:75], v1, s[4:7], s50 offen nt
  buffer_load_dwordx4 a[76:79], v2, s[4:7], s50 offen nt
  buffer_load_dwordx4 a[80:83], v7, s[4:7], s50 offen nt
  s_add_u32 s50, s50, 98304
  buffer_load_dwordx4 a[84:87], v1, s[4:7], s50 offen nt
  buffer_load_dwordx4 a[88:91], v2, s[4:7], s50 offen nt
  buffer_load_dwordx4 a[92:95], v7, s[4:7], s50 offen nt
  s_add_u32 s50, s50, 98304
  buffer_load_dwordx4 v[120:123], v1, s[4:7], s50 offen nt
  buffer_load_dwordx4 v[124:127], v2, s[4:7], s50 offen nt
  buffer_load_dwordx4 v[128:131], v7, s[4:7], s50 offen nt
  s_add_u32 s50, s50, 98304
  buffer_load_dwordx4 v[132:135], v1, s[4:7], s50 offen nt
  buffer_load_dwordx4 v[136:139], v2, s[4:7], s50 offen nt
  buffer_load_dwordx4 v[140:143], v7, s[4:7], s50 offen nt
  s_barrier
  s_mov_b32 s12, s44
  s_and_b32 s13, s45, 0xffff
  s_mov_b32 s14, 3145728
  s_mov_b32 s15, 0x20000
  s_mov_b32 s56, 0xaaaaaaaa
  s_mov_b32 s57, 0xaaaaaaaa
  s_mov_b32 s58, 0xff00ff00
  s_mov_b32 s59, 0xff00ff00
  s_mov_b32 s60, 0x3fb8aa3b
  s_mov_b32 s61, 0x3d93cd3a
  s_mov_b32 s62, 0xffff0000
  v_and_b32 v10, 1, v0
  v_mov_b32 v11, 0xffff
  v_lshlrev_b32 v10, 4, v10
  v_lshlrev_b32 v11, v10, v11
  v_bfe_u32 v10, v0, 1, 2
  v_cmp_eq_u32 vcc, 0, v10
  s_nop 1
  v_cndmask_b32 v3, 0, v11, vcc
  v_cmp_eq_u32 vcc, 1, v10
  s_nop 1
  v_cndmask_b32 v4, 0, v11, vcc
  v_cmp_eq_u32 vcc, 2, v10
  s_nop 1
  v_cndmask_b32 v5, 0, v11, vcc
  v_cmp_eq_u32 vcc, 3, v10
  s_nop 1
  v_cndmask_b32 v6, 0, v11, vcc
  s_mov_b32 s63, 1792
  v_and_b32 v10, 15, v0
  v_lshrrev_b32 v11, 4, v0
  v_and_b32 v20, 1, v11
  v_lshlrev_b32 v20, 4, v20
  v_lshl_add_u32 v20, v10, 5, v20
  v_add_u32 v20, s63, v20
  v_lshlrev_b32 v21, 4, v0
  v_add_u32 v21, 3328, v21
  v_cmp_gt_u32 vcc, 32, v0
  s_nop 1
  v_cndmask_b32 v60, v21, v20, vcc
  v_add_u32 v22, 1024, v20
  v_cndmask_b32 v62, v22, v21, vcc
  v_add_u32 v22, 512, v20
  v_lshrrev_b32 v10, 3, v10
  v_lshrrev_b32 v11, 1, v11
  v_cmp_eq_u32 vcc, v10, v11
  s_nop 1
  v_cndmask_b32 v61, v21, v22, vcc
  s_waitcnt vmcnt(30)
  v_lshlrev_b32 v44, 16, v24
  v_and_b32 v45, s62, v24
  v_lshlrev_b32 v46, 16, v25
  v_and_b32 v47, s62, v25
  v_lshlrev_b32 v48, 16, v26
  v_and_b32 v49, s62, v26
  v_lshlrev_b32 v50, 16, v27
  v_and_b32 v51, s62, v27
  v_lshlrev_b32 v52, 16, v28
  v_and_b32 v53, s62, v28
  v_add_f32 v10, v44, v45
  v_add_f32 v10, v10, v46
  v_add_f32 v10, v10, v47
  v_add_f32 v10, v10, v48
  v_add_f32 v10, v10, v49
  v_add_f32 v10, v10, v50
  v_add_f32 v10, v10, v51
  v_add_f32 v10, v10, v52
  v_add_f32 v10, v10, v53
  s_nop 1
  v_add_f32_dpp v10, v10, v10 quad_perm:[1,0,3,2] row_mask:0xf bank_mask:0xf
  s_nop 1
  v_add_f32_dpp v10, v10, v10 quad_perm:[2,3,0,1] row_mask:0xf bank_mask:0xf
  s_nop 1
  v_add_f32_dpp v10, v10, v10 row_half_mirror row_mask:0xf bank_mask:0xf
  s_nop 1
  v_add_f32_dpp v10, v10, v10 row_mirror row_mask:0xf bank_mask:0xf
  v_mov_b32 v11, v10
  s_nop 1
  v_permlane16_swap_b32 v10, v11
  v_add_f32 v10, v10, v11
  v_mov_b32 v11, v10
  s_nop 1
  v_permlane32_swap_b32 v10, v11
  v_add_f32 v10, v10, v11
  v_mul_f32 v10, 0x3acccccd, v10
  v_sub_f32 v44, v44, v10
  v_sub_f32 v45, v45, v10
  v_sub_f32 v46, v46, v10
  v_sub_f32 v47, v47, v10
  v_sub_f32 v48, v48, v10
  v_sub_f32 v49, v49, v10
  v_sub_f32 v50, v50, v10
  v_sub_f32 v51, v51, v10
  v_sub_f32 v52, v52, v10
  v_sub_f32 v53, v53, v10
  v_mul_f32 v20, v44, v44
  v_fmac_f32 v20, v45, v45
  v_fmac_f32 v20, v46, v46
  v_fmac_f32 v20, v47, v47
  v_fmac_f32 v20, v48, v48
  v_fmac_f32 v20, v49, v49
  v_fmac_f32 v20, v50, v50
  v_fmac_f32 v20, v51, v51
  v_fmac_f32 v20, v52, v52
  v_fmac_f32 v20, v53, v53
  s_nop 1
  v_add_f32_dpp v20, v20, v20 quad_perm:[1,0,3,2] row_mask:0xf bank_mask:0xf
  s_nop 1
  v_add_f32_dpp v20, v20, v20 quad_perm:[2,3,0,1] row_mask:0xf bank_mask:0xf
  s_nop 1
  v_add_f32_dpp v20, v20, v20 row_half_mirror row_mask:0xf bank_mask:0xf
  s_nop 1
  v_add_f32_dpp v20, v20, v20 row_mirror row_mask:0xf bank_mask:0xf
  v_mov_b32 v11, v20
  s_nop 1
  v_permlane16_swap_b32 v20, v11
  v_add_f32 v20, v20, v11
  v_mov_b32 v11, v20
  s_nop 1
  v_permlane32_swap_b32 v20, v11
  v_add_f32 v20, v20, v11
  v_mul_f32 v20, 0x3acccccd, v20
  v_cvt_pk_bf16_f32 v21, v10, v10
  v_and_b32 v21, s62, v21
  v_cvt_pk_bf16_f32 v20, v20, v20
  v_and_b32 v20, s62, v20
  v_add_f32 v20, 0x3727c5ac, v20
  v_cvt_pk_bf16_f32 v20, v20, v20
  v_and_b32 v20, s62, v20
  v_sqrt_f32 v20, v20
  s_nop 0
  v_cvt_pk_bf16_f32 v20, v20, v20
  v_and_b32 v20, s62, v20
  v_rcp_f32 v22, v20
  v_lshlrev_b32 v32, 16, v32
  v_sub_f32 v32, v32, v21
  v_cvt_pk_bf16_f32 v32, v32, v32
  v_and_b32 v32, s62, v32
  v_mul_f32 v32, v32, v22
  v_cvt_pk_bf16_f32 v32, v32, v32
  v_lshlrev_b32 v33, 16, v33
  v_sub_f32 v33, v33, v21
  v_cvt_pk_bf16_f32 v33, v33, v33
  v_and_b32 v33, s62, v33
  v_mul_f32 v33, v33, v22
  v_cvt_pk_bf16_f32 v33, v33, v33
  v_lshlrev_b32 v34, 16, v34
  v_sub_f32 v34, v34, v21
  v_cvt_pk_bf16_f32 v34, v34, v34
  v_and_b32 v34, s62, v34
  v_mul_f32 v34, v34, v22
  v_cvt_pk_bf16_f32 v34, v34, v34
  v_lshlrev_b32 v35, 16, v35
  v_sub_f32 v35, v35, v21
  v_cvt_pk_bf16_f32 v35, v35, v35
  v_and_b32 v35, s62, v35
  v_mul_f32 v35, v35, v22
  v_cvt_pk_bf16_f32 v35, v35, v35
  v_lshlrev_b32 v36, 16, v36
  v_sub_f32 v36, v36, v21
  v_cvt_pk_bf16_f32 v36, v36, v36
  v_and_b32 v36, s62, v36
  v_mul_f32 v36, v36, v22
  v_cvt_pk_bf16_f32 v36, v36, v36
  v_lshlrev_b32 v37, 16, v37
  v_sub_f32 v37, v37, v21
  v_cvt_pk_bf16_f32 v37, v37, v37
  v_and_b32 v37, s62, v37
  v_mul_f32 v37, v37, v22
  v_cvt_pk_bf16_f32 v37, v37, v37
  v_lshlrev_b32 v38, 16, v38
  v_sub_f32 v38, v38, v21
  v_cvt_pk_bf16_f32 v38, v38, v38
  v_and_b32 v38, s62, v38
  v_mul_f32 v38, v38, v22
  v_cvt_pk_bf16_f32 v38, v38, v38
  v_lshlrev_b32 v39, 16, v39
  v_sub_f32 v39, v39, v21
  v_cvt_pk_bf16_f32 v39, v39, v39
  v_and_b32 v39, s62, v39
  v_mul_f32 v39, v39, v22
  v_cvt_pk_bf16_f32 v39, v39, v39
  v_lshlrev_b32 v40, 16, v40
  v_sub_f32 v40, v40, v21
  v_cvt_pk_bf16_f32 v40, v40, v40
  v_and_b32 v40, s62, v40
  v_mul_f32 v40, v40, v22
  v_cvt_pk_bf16_f32 v40, v40, v40
  v_lshlrev_b32 v41, 16, v41
  v_sub_f32 v41, v41, v21
  v_cvt_pk_bf16_f32 v41, v41, v41
  v_and_b32 v41, s62, v41
  v_mul_f32 v41, v41, v22
  v_cvt_pk_bf16_f32 v41, v41, v41
  v_and_b32 v16, v32, v3
  v_and_b32 v17, v32, v4
  v_and_b32 v18, v32, v5
  v_and_b32 v19, v32, v6
  s_waitcnt vmcnt(27)
  s_nop 0
  v_mfma_f32_16x16x32_bf16 v[64:67], v[16:19], a[0:3], 0
  v_mfma_f32_16x16x32_bf16 v[68:71], v[16:19], a[4:7], 0
  v_mfma_f32_16x16x32_bf16 v[72:75], v[16:19], a[8:11], 0
  v_and_b32 v16, v33, v3
  v_and_b32 v17, v33, v4
  v_and_b32 v18, v33, v5
  v_and_b32 v19, v33, v6
  s_waitcnt vmcnt(24)
  s_nop 0
  v_mfma_f32_16x16x32_bf16 v[64:67], v[16:19], a[12:15], v[64:67]
  v_mfma_f32_16x16x32_bf16 v[68:71], v[16:19], a[16:19], v[68:71]
  v_mfma_f32_16x16x32_bf16 v[72:75], v[16:19], a[20:23], v[72:75]
  v_and_b32 v16, v34, v3
  v_and_b32 v17, v34, v4
  v_and_b32 v18, v34, v5
  v_and_b32 v19, v34, v6
  s_waitcnt vmcnt(21)
  s_nop 0
  v_mfma_f32_16x16x32_bf16 v[64:67], v[16:19], a[24:27], v[64:67]
  v_mfma_f32_16x16x32_bf16 v[68:71], v[16:19], a[28:31], v[68:71]
  v_mfma_f32_16x16x32_bf16 v[72:75], v[16:19], a[32:35], v[72:75]
  v_and_b32 v16, v35, v3
  v_and_b32 v17, v35, v4
  v_and_b32 v18, v35, v5
  v_and_b32 v19, v35, v6
  s_waitcnt vmcnt(18)
  s_nop 0
  v_mfma_f32_16x16x32_bf16 v[64:67], v[16:19], a[36:39], v[64:67]
  v_mfma_f32_16x16x32_bf16 v[68:71], v[16:19], a[40:43], v[68:71]
  v_mfma_f32_16x16x32_bf16 v[72:75], v[16:19], a[44:47], v[72:75]
  v_and_b32 v16, v36, v3
  v_and_b32 v17, v36, v4
  v_and_b32 v18, v36, v5
  v_and_b32 v19, v36, v6
  s_waitcnt vmcnt(15)
  s_nop 0
  v_mfma_f32_16x16x32_bf16 v[64:67], v[16:19], a[48:51], v[64:67]
  v_mfma_f32_16x16x32_bf16 v[68:71], v[16:19], a[52:55], v[68:71]
  v_mfma_f32_16x16x32_bf16 v[72:75], v[16:19], a[56:59], v[72:75]
  v_and_b32 v16, v37, v3
  v_and_b32 v17, v37, v4
  v_and_b32 v18, v37, v5
  v_and_b32 v19, v37, v6
  s_waitcnt vmcnt(12)
  s_nop 0
  v_mfma_f32_16x16x32_bf16 v[64:67], v[16:19], a[60:63], v[64:67]
  v_mfma_f32_16x16x32_bf16 v[68:71], v[16:19], a[64:67], v[68:71]
  v_mfma_f32_16x16x32_bf16 v[72:75], v[16:19], a[68:71], v[72:75]
  v_and_b32 v16, v38, v3
  v_and_b32 v17, v38, v4
  v_and_b32 v18, v38, v5
  v_and_b32 v19, v38, v6
  s_waitcnt vmcnt(9)
  s_nop 0
  v_mfma_f32_16x16x32_bf16 v[64:67], v[16:19], a[72:75], v[64:67]
  v_mfma_f32_16x16x32_bf16 v[68:71], v[16:19], a[76:79], v[68:71]
  v_mfma_f32_16x16x32_bf16 v[72:75], v[16:19], a[80:83], v[72:75]
  v_and_b32 v16, v39, v3
  v_and_b32 v17, v39, v4
  v_and_b32 v18, v39, v5
  v_and_b32 v19, v39, v6
  s_waitcnt vmcnt(6)
  s_nop 0
  v_mfma_f32_16x16x32_bf16 v[64:67], v[16:19], a[84:87], v[64:67]
  v_mfma_f32_16x16x32_bf16 v[68:71], v[16:19], a[88:91], v[68:71]
  v_mfma_f32_16x16x32_bf16 v[72:75], v[16:19], a[92:95], v[72:75]
  v_and_b32 v16, v40, v3
  v_and_b32 v17, v40, v4
  v_and_b32 v18, v40, v5
  v_and_b32 v19, v40, v6
  s_waitcnt vmcnt(3)
  s_nop 0
  v_mfma_f32_16x16x32_bf16 v[64:67], v[16:19], v[120:123], v[64:67]
  v_mfma_f32_16x16x32_bf16 v[68:71], v[16:19], v[124:127], v[68:71]
  v_mfma_f32_16x16x32_bf16 v[72:75], v[16:19], v[128:131], v[72:75]
  v_and_b32 v16, v41, v3
  v_and_b32 v17, v41, v4
  v_and_b32 v18, v41, v5
  v_and_b32 v19, v41, v6
  s_waitcnt vmcnt(0)
  s_nop 0
  v_mfma_f32_16x16x32_bf16 v[64:67], v[16:19], v[132:135], v[64:67]
  v_mfma_f32_16x16x32_bf16 v[68:71], v[16:19], v[136:139], v[68:71]
  v_mfma_f32_16x16x32_bf16 v[72:75], v[16:19], v[140:143], v[72:75]
  s_waitcnt lgkmcnt(0)
  s_mul_i32 s46, s46, 1664525
  s_add_u32 s46, s46, 1013904223
  s_lshl_b32 s63, s66, 3
  s_add_u32 s63, s63, s65
  s_lshl_b32 s63, s63, 10
  s_add_u32 s63, s63, 65536
  s_lshl_b32 s64, s48, 13
  s_add_u32 s64, s64, 65536
  s_add_u32 s65, s64, 4096
  v_lshlrev_b32 v2, 4, v0
  v_lshlrev_b32 v7, 1, v0
  ds_write_b128 v60, v[64:67]
  ds_write_b128 v61, v[68:71]
  ds_write_b128 v62, v[72:75]
  s_waitcnt lgkmcnt(0)
  ds_read2st64_b32 v[24:25], v8 offset0:7 offset1:10
  ds_read2st64_b32 v[26:27], v8 offset0:8 offset1:11
  ds_read2st64_b32 v[28:29], v8 offset0:9 offset1:12
  v_mov_b32 v35, s46
  s_waitcnt lgkmcnt(0)
  v_add_f32 v32, v24, v25
  v_add_f32 v33, v26, v27
  v_add_f32 v34, v28, v29
  buffer_store_dwordx4 v[32:35], v2, s[12:15], s63 offen sc1
  v_mov_b32 v147, 1536
  v_mov_b32 v148, 1
  s_mov_b32 s79, 0
  s_mov_b32 s78, 1000000
L_f1:
  ds_read_b32 v9, v147 offset:76
  s_sub_u32 s78, s78, 1
  s_cbranch_scc1 L_f1_x
  s_waitcnt lgkmcnt(0)
  v_readfirstlane_b32 s63, v9
  s_nop 0
  s_cmp_ge_u32 s63, 1
  s_cbranch_scc1 L_f1_x
  s_sleep 4
  s_branch L_f1
L_f1_x:
  s_waitcnt lgkmcnt(0)
L_hq:
  s_mov_b32 s78, 1000000
L_p2:
  buffer_load_dwordx4 v[112:115], v2, s[12:15], s64 offen offset:0 sc1
  buffer_load_dwordx4 v[116:119], v2, s[12:15], s64 offen offset:1024 sc1
  buffer_load_dwordx4 v[120:123], v2, s[12:15], s64 offen offset:2048 sc1
  buffer_load_dwordx4 v[124:127], v2, s[12:15], s64 offen offset:3072 sc1
  buffer_load_dwordx4 v[128:131], v2, s[12:15], s65 offen offset:0 sc1
  buffer_load_dwordx4 v[132:135], v2, s[12:15], s65 offen offset:1024 sc1
  buffer_load_dwordx4 v[136:139], v2, s[12:15], s65 offen offset:2048 sc1
  buffer_load_dwordx4 v[140:143], v2, s[12:15], s65 offen offset:3072 sc1
  s_sub_u32 s78, s78, 1
  s_cbranch_scc1 L_p2_x
  s_waitcnt vmcnt(0)
  v_min_u32 v10, v115, v143
  v_max_u32 v11, v115, v143
  v_min3_u32 v10, v10, v119, v123
  v_max3_u32 v11, v11, v119, v123
  v_min3_u32 v10, v10, v127, v131
  v_max3_u32 v11, v11, v127, v131
  v_min3_u32 v10, v10, v135, v139
  v_max3_u32 v11, v11, v135, v139
  v_cmp_ne_u32 vcc, s46, v10
  v_cmp_ne_u32 s[80:81], s46, v11
  s_nop 0
  s_or_b64 vcc, vcc, s[80:81]
  s_cbranch_vccz L_p2_x
  s_sleep 32
  s_branch L_p2
L_p2_x:
  s_waitcnt vmcnt(0)
  v_add_f32 v24, v112, v116
  v_add_f32 v24, v24, v120
  v_add_f32 v24, v24, v124
  v_add_f32 v24, v24, v128
  v_add_f32 v24, v24, v132
  v_add_f32 v24, v24, v136
  v_add_f32 v24, v24, v140
  v_cvt_pk_bf16_f32 v24, v24, v24
  v_add_f32 v25, v113, v117
  v_add_f32 v25, v25, v121
  v_add_f32 v25, v25, v125
  v_add_f32 v25, v25, v129
  v_add_f32 v25, v25, v133
  v_add_f32 v25, v25, v137
  v_add_f32 v25, v25, v141
  v_cvt_pk_bf16_f32 v25, v25, v25
  v_add_f32 v26, v114, v118
  v_add_f32 v26, v26, v122
  v_add_f32 v26, v26, v126
  v_add_f32 v26, v26, v130
  v_add_f32 v26, v26, v134
  v_add_f32 v26, v26, v138
  v_add_f32 v26, v26, v142
  v_cvt_pk_bf16_f32 v26, v26, v26
  ds_write_b16 v7, v24 offset:0
  ds_write_b16 v7, v25 offset:128
  ds_write_b16 v7, v26 offset:256
  s_cmp_lg_u32 s79, 0
  s_cbranch_scc1 L_hq_nb
  s_waitcnt lgkmcnt(0)
  s_barrier
L_hq_nb:
  v_add_u32 v7, 384, v7
  s_add_u32 s64, s64, 0x10000
  s_lshl_b32 s63, s96, 13
  s_add_u32 s63, s63, 262144
  s_cmp_eq_u32 s79, 2
  s_cselect_b32 s64, s63, s64
  s_add_u32 s65, s64, 4096
  s_add_u32 s79, s79, 1
  s_cmp_lt_u32 s79, 4
  s_cbranch_scc1 L_hq
  s_mov_b64 exec, 1
  ds_add_u32 v147, v148 offset:60
  s_mov_b64 exec, -1
  s_lshl_b32 s63, s47, 2
  s_add_u32 s63, s63, s48
  s_lshl_b32 s63, s63, 8
  s_add_u32 s63, s63, 655360
  s_lshl_b32 s72, s96, 8
  s_add_u32 s72, s72, 4096
  s_cmp_lt_u32 s48, 4
  s_cbranch_scc1 L_hinit
  s_lshl_b32 s63, s47, 8
  s_add_u32 s63, s63, 8192
  s_cmp_eq_u32 s48, 5
  s_cbranch_scc1 L_hinit
  s_mov_b32 s63, s72
  s_cmp_lg_u32 s97, 16
  s_cbranch_scc1 L_hnoinit
L_hinit:
  v_mov_b32 v24, 0
  v_mov_b32 v25, s46
  v_mov_b32 v26, 0
  v_mov_b32 v27, 0
  s_mov_b64 exec, 15
  buffer_store_dwordx4 v[24:27], v2, s[12:15], s63 offen sc1
  s_mov_b64 exec, -1
L_hnoinit:
  s_mov_b32 s99, s72
  v_add_u32 v149, 8192, v2
  v_and_b32 v150, 31, v0
  v_lshlrev_b32 v150, 6, v150
  v_mov_b32 v47, s46
  s_getreg_b32 s98, hwreg(HW_REG_XCC_ID)
  v_mov_b32 v46, s98
  s_lshl_b32 s64, s48, 11
  s_add_u32 s64, s64, 589824
  s_lshl_b32 s65, s47, 6
  s_add_u32 s65, s65, s64
  s_mov_b32 s78, 1000000
L_f3:
  ds_read_b32 v9, v147 offset:0
  s_sub_u32 s78, s78, 1
  s_cbranch_scc1 L_f3_x
  s_waitcnt lgkmcnt(0)
  v_readfirstlane_b32 s63, v9
  s_nop 0
  s_cmp_ge_u32 s63, 4
  s_cbranch_scc1 L_f3_x
  s_sleep 8
  s_branch L_f3
L_f3_x:
  s_waitcnt lgkmcnt(0)
  ds_read_b128 v[24:27], v149 offset:0
  ds_read_b128 v[28:31], v149 offset:1024
  ds_read_b128 v[32:35], v149 offset:2048
  ds_read_b128 v[36:39], v149 offset:3072
  s_waitcnt lgkmcnt(0)
  v_max3_f32 v44, v24, v25, v26
  v_max3_f32 v44, v44, v27, v28
  v_max3_f32 v44, v44, v29, v30
  v_max3_f32 v44, v44, v31, v32
  v_max3_f32 v44, v44, v33, v34
  v_max3_f32 v44, v44, v35, v36
  v_max3_f32 v44, v44, v37, v38
  v_max_f32 v44, v44, v39
  s_nop 1
  v_max_f32_dpp v44, v44, v44 quad_perm:[1,0,3,2] row_mask:0xf bank_mask:0xf
  s_nop 1
  v_max_f32_dpp v44, v44, v44 quad_perm:[2,3,0,1] row_mask:0xf bank_mask:0xf
  s_nop 1
  v_max_f32_dpp v44, v44, v44 row_half_mirror row_mask:0xf bank_mask:0xf
  s_nop 1
  v_max_f32_dpp v44, v44, v44 row_mirror row_mask:0xf bank_mask:0xf
  v_mov_b32 v11, v44
  s_nop 1
  v_permlane16_swap_b32 v44, v11
  v_max_f32 v44, v44, v11
  v_mov_b32 v11, v44
  s_nop 1
  v_permlane32_swap_b32 v44, v11
  v_max_f32 v44, v44, v11
  v_sub_f32 v24, v24, v44
  v_sub_f32 v25, v25, v44
  v_sub_f32 v26, v26, v44
  v_sub_f32 v27, v27, v44
  v_sub_f32 v28, v28, v44
  v_sub_f32 v29, v29, v44
  v_sub_f32 v30, v30, v44
  v_sub_f32 v31, v31, v44
  v_sub_f32 v32, v32, v44
  v_sub_f32 v33, v33, v44
  v_sub_f32 v34, v34, v44
  v_sub_f32 v35, v35, v44
  v_sub_f32 v36, v36, v44
  v_sub_f32 v37, v37, v44
  v_sub_f32 v38, v38, v44
  v_sub_f32 v39, v39, v44
  v_mul_f32 v24, s60, v24
  v_mul_f32 v25, s60, v25
  v_mul_f32 v26, s60, v26
  v_mul_f32 v27, s60, v27
  v_mul_f32 v28, s60, v28
  v_mul_f32 v29, s60, v29
  v_mul_f32 v30, s60, v30
  v_mul_f32 v31, s60, v31
  v_mul_f32 v32, s60, v32
  v_mul_f32 v33, s60, v33
  v_mul_f32 v34, s60, v34
  v_mul_f32 v35, s60, v35
  v_mul_f32 v36, s60, v36
  v_mul_f32 v37, s60, v37
  v_mul_f32 v38, s60, v38
  v_mul_f32 v39, s60, v39
  v_exp_f32 v24, v24
  v_exp_f32 v25, v25
  v_exp_f32 v26, v26
  v_exp_f32 v27, v27
  v_exp_f32 v28, v28
  v_exp_f32 v29, v29
  v_exp_f32 v30, v30
  v_exp_f32 v31, v31
  v_exp_f32 v32, v32
  v_exp_f32 v33, v33
  v_exp_f32 v34, v34
  v_exp_f32 v35, v35
  v_exp_f32 v36, v36
  v_exp_f32 v37, v37
  v_exp_f32 v38, v38
  v_exp_f32 v39, v39
  v_add_f32 v45, v24, v25
  v_add_f32 v45, v45, v26
  v_add_f32 v45, v45, v27
  v_add_f32 v45, v45, v28
  v_add_f32 v45, v45, v29
  v_add_f32 v45, v45, v30
  v_add_f32 v45, v45, v31
  v_add_f32 v45, v45, v32
  v_add_f32 v45, v45, v33
  v_add_f32 v45, v45, v34
  v_add_f32 v45, v45, v35
  v_add_f32 v45, v45, v36
  v_add_f32 v45, v45, v37
  v_add_f32 v45, v45, v38
  v_add_f32 v45, v45, v39
  s_nop 1
  v_add_f32_dpp v45, v45, v45 quad_perm:[1,0,3,2] row_mask:0xf bank_mask:0xf
  s_nop 1
  v_add_f32_dpp v45, v45, v45 quad_perm:[2,3,0,1] row_mask:0xf bank_mask:0xf
  s_nop 1
  v_add_f32_dpp v45, v45, v45 row_half_mirror row_mask:0xf bank_mask:0xf
  s_nop 1
  v_add_f32_dpp v45, v45, v45 row_mirror row_mask:0xf bank_mask:0xf
  v_mov_b32 v11, v45
  s_nop 1
  v_permlane16_swap_b32 v45, v11
  v_add_f32 v45, v45, v11
  v_mov_b32 v11, v45
  s_nop 1
  v_permlane32_swap_b32 v45, v11
  v_add_f32 v45, v45, v11
  s_add_u32 s63, s65, 0
  s_mov_b64 exec, 15
  buffer_store_dwordx4 v[44:47], v2, s[12:15], s63 offen sc1
  s_mov_b64 exec, -1
  s_mov_b32 s78, 1000000
L_f4:
  ds_read_b32 v9, v147 offset:4
  s_sub_u32 s78, s78, 1
  s_cbranch_scc1 L_f4_x
  s_waitcnt lgkmcnt(0)
  v_readfirstlane_b32 s63, v9
  s_nop 0
  s_cmp_ge_u32 s63, 4
  s_cbranch_scc1 L_f4_x
  s_sleep 8
  s_branch L_f4
L_f4_x:
  s_waitcnt lgkmcnt(0)
  ds_read_b128 v[24:27], v149 offset:4096
  ds_read_b128 v[28:31], v149 offset:5120
  ds_read_b128 v[32:35], v149 offset:6144
  ds_read_b128 v[36:39], v149 offset:7168
  s_waitcnt lgkmcnt(0)
  v_max3_f32 v44, v24, v25, v26
  v_max3_f32 v44, v44, v27, v28
  v_max3_f32 v44, v44, v29, v30
  v_max3_f32 v44, v44, v31, v32
  v_max3_f32 v44, v44, v33, v34
  v_max3_f32 v44, v44, v35, v36
  v_max3_f32 v44, v44, v37, v38
  v_max_f32 v44, v44, v39
  s_nop 1
  v_max_f32_dpp v44, v44, v44 quad_perm:[1,0,3,2] row_mask:0xf bank_mask:0xf
  s_nop 1
  v_max_f32_dpp v44, v44, v44 quad_perm:[2,3,0,1] row_mask:0xf bank_mask:0xf
  s_nop 1
  v_max_f32_dpp v44, v44, v44 row_half_mirror row_mask:0xf bank_mask:0xf
  s_nop 1
  v_max_f32_dpp v44, v44, v44 row_mirror row_mask:0xf bank_mask:0xf
  v_mov_b32 v11, v44
  s_nop 1
  v_permlane16_swap_b32 v44, v11
  v_max_f32 v44, v44, v11
  v_mov_b32 v11, v44
  s_nop 1
  v_permlane32_swap_b32 v44, v11
  v_max_f32 v44, v44, v11
  v_sub_f32 v24, v24, v44
  v_sub_f32 v25, v25, v44
  v_sub_f32 v26, v26, v44
  v_sub_f32 v27, v27, v44
  v_sub_f32 v28, v28, v44
  v_sub_f32 v29, v29, v44
  v_sub_f32 v30, v30, v44
  v_sub_f32 v31, v31, v44
  v_sub_f32 v32, v32, v44
  v_sub_f32 v33, v33, v44
  v_sub_f32 v34, v34, v44
  v_sub_f32 v35, v35, v44
  v_sub_f32 v36, v36, v44
  v_sub_f32 v37, v37, v44
  v_sub_f32 v38, v38, v44
  v_sub_f32 v39, v39, v44
  v_mul_f32 v24, s60, v24
  v_mul_f32 v25, s60, v25
  v_mul_f32 v26, s60, v26
  v_mul_f32 v27, s60, v27
  v_mul_f32 v28, s60, v28
  v_mul_f32 v29, s60, v29
  v_mul_f32 v30, s60, v30
  v_mul_f32 v31, s60, v31
  v_mul_f32 v32, s60, v32
  v_mul_f32 v33, s60, v33
  v_mul_f32 v34, s60, v34
  v_mul_f32 v35, s60, v35
  v_mul_f32 v36, s60, v36
  v_mul_f32 v37, s60, v37
  v_mul_f32 v38, s60, v38
  v_mul_f32 v39, s60, v39
  v_exp_f32 v24, v24
  v_exp_f32 v25, v25
  v_exp_f32 v26, v26
  v_exp_f32 v27, v27
  v_exp_f32 v28, v28
  v_exp_f32 v29, v29
  v_exp_f32 v30, v30
  v_exp_f32 v31, v31
  v_exp_f32 v32, v32
  v_exp_f32 v33, v33
  v_exp_f32 v34, v34
  v_exp_f32 v35, v35
  v_exp_f32 v36, v36
  v_exp_f32 v37, v37
  v_exp_f32 v38, v38
  v_exp_f32 v39, v39
  v_add_f32 v45, v24, v25
  v_add_f32 v45, v45, v26
  v_add_f32 v45, v45, v27
  v_add_f32 v45, v45, v28
  v_add_f32 v45, v45, v29
  v_add_f32 v45, v45, v30
  v_add_f32 v45, v45, v31
  v_add_f32 v45, v45, v32
  v_add_f32 v45, v45, v33
  v_add_f32 v45, v45, v34
  v_add_f32 v45, v45, v35
  v_add_f32 v45, v45, v36
  v_add_f32 v45, v45, v37
  v_add_f32 v45, v45, v38
  v_add_f32 v45, v45, v39
  s_nop 1
  v_add_f32_dpp v45, v45, v45 quad_perm:[1,0,3,2] row_mask:0xf bank_mask:0xf
  s_nop 1
  v_add_f32_dpp v45, v45, v45 quad_perm:[2,3,0,1] row_mask:0xf bank_mask:0xf
  s_nop 1
  v_add_f32_dpp v45, v45, v45 row_half_mirror row_mask:0xf bank_mask:0xf
  s_nop 1
  v_add_f32_dpp v45, v45, v45 row_mirror row_mask:0xf bank_mask:0xf
  v_mov_b32 v11, v45
  s_nop 1
  v_permlane16_swap_b32 v45, v11
  v_add_f32 v45, v45, v11
  v_mov_b32 v11, v45
  s_nop 1
  v_permlane32_swap_b32 v45, v11
  v_add_f32 v45, v45, v11
  s_add_u32 s63, s65, 16384
  s_mov_b64 exec, 15
  buffer_store_dwordx4 v[44:47], v2, s[12:15], s63 offen sc1
  s_mov_b64 exec, -1
  s_add_u32 s66, s64, 0
  s_mov_b32 s78, 1000000
L_p5:
  buffer_load_dwordx4 v[40:43], v150, s[12:15], s66 offen sc1
  s_sub_u32 s78, s78, 1
  s_cbranch_scc1 L_p5_x
  s_waitcnt vmcnt(0)
  v_cmp_ne_u32 vcc, s46, v43
  s_cbranch_vccz L_p5_x
  s_sleep 32
  s_branch L_p5
L_p5_x:
  s_waitcnt vmcnt(0)
  v_cmp_ne_u32 vcc, s98, v42
  s_nop 0
  s_cmp_eq_u64 vcc, 0
  s_cselect_b32 s98, s98, -1
  ds_read_b128 v[24:27], v149 offset:0
  ds_read_b128 v[28:31], v149 offset:1024
  ds_read_b128 v[32:35], v149 offset:2048
  ds_read_b128 v[36:39], v149 offset:3072
  s_waitcnt lgkmcnt(0)
  v_mov_b32 v44, v40
  s_nop 1
  v_max_f32_dpp v44, v44, v44 quad_perm:[1,0,3,2] row_mask:0xf bank_mask:0xf
  s_nop 1
  v_max_f32_dpp v44, v44, v44 quad_perm:[2,3,0,1] row_mask:0xf bank_mask:0xf
  s_nop 1
  v_max_f32_dpp v44, v44, v44 row_half_mirror row_mask:0xf bank_mask:0xf
  s_nop 1
  v_max_f32_dpp v44, v44, v44 row_mirror row_mask:0xf bank_mask:0xf
  v_mov_b32 v11, v44
  s_nop 1
  v_permlane16_swap_b32 v44, v11
  v_max_f32 v44, v44, v11
  v_mov_b32 v11, v44
  s_nop 1
  v_permlane32_swap_b32 v44, v11
  v_max_f32 v44, v44, v11
  v_sub_f32 v40, v40, v44
  v_mul_f32 v40, s60, v40
  v_exp_f32 v40, v40
  s_nop 0
  v_mul_f32 v45, v40, v41
  s_nop 1
  v_add_f32_dpp v45, v45, v45 quad_perm:[1,0,3,2] row_mask:0xf bank_mask:0xf
  s_nop 1
  v_add_f32_dpp v45, v45, v45 quad_perm:[2,3,0,1] row_mask:0xf bank_mask:0xf
  s_nop 1
  v_add_f32_dpp v45, v45, v45 row_half_mirror row_mask:0xf bank_mask:0xf
  s_nop 1
  v_add_f32_dpp v45, v45, v45 row_mirror row_mask:0xf bank_mask:0xf
  v_mov_b32 v11, v45
  s_nop 1
  v_permlane16_swap_b32 v45, v11
  v_add_f32 v45, v45, v11
  v_mov_b32 v11, v45
  s_nop 1
  v_permlane32_swap_b32 v45, v11
  v_add_f32 v45, v45, v11
  v_mul_f32 v45, 0.5, v45
  v_rcp_f32 v45, v45
  v_sub_f32 v24, v24, v44
  v_sub_f32 v25, v25, v44
  v_sub_f32 v26, v26, v44
  v_sub_f32 v27, v27, v44
  v_sub_f32 v28, v28, v44
  v_sub_f32 v29, v29, v44
  v_sub_f32 v30, v30, v44
  v_sub_f32 v31, v31, v44
  v_sub_f32 v32, v32, v44
  v_sub_f32 v33, v33, v44
  v_sub_f32 v34, v34, v44
  v_sub_f32 v35, v35, v44
  v_sub_f32 v36, v36, v44
  v_sub_f32 v37, v37, v44
  v_sub_f32 v38, v38, v44
  v_sub_f32 v39, v39, v44
  v_mul_f32 v24, s60, v24
  v_mul_f32 v25, s60, v25
  v_mul_f32 v26, s60, v26
  v_mul_f32 v27, s60, v27
  v_mul_f32 v28, s60, v28
  v_mul_f32 v29, s60, v29
  v_mul_f32 v30, s60, v30
  v_mul_f32 v31, s60, v31
  v_mul_f32 v32, s60, v32
  v_mul_f32 v33, s60, v33
  v_mul_f32 v34, s60, v34
  v_mul_f32 v35, s60, v35
  v_mul_f32 v36, s60, v36
  v_mul_f32 v37, s60, v37
  v_mul_f32 v38, s60, v38
  v_mul_f32 v39, s60, v39
  v_exp_f32 v24, v24
  v_exp_f32 v25, v25
  v_exp_f32 v26, v26
  v_exp_f32 v27, v27
  v_exp_f32 v28, v28
  v_exp_f32 v29, v29
  v_exp_f32 v30, v30
  v_exp_f32 v31, v31
  v_exp_f32 v32, v32
  v_exp_f32 v33, v33
  v_exp_f32 v34, v34
  v_exp_f32 v35, v35
  v_exp_f32 v36, v36
  v_exp_f32 v37, v37
  v_exp_f32 v38, v38
  v_exp_f32 v39, v39
  v_mul_f32 v24, v24, v45
  v_mul_f32 v25, v25, v45
  v_mul_f32 v26, v26, v45
  v_mul_f32 v27, v27, v45
  v_mul_f32 v28, v28, v45
  v_mul_f32 v29, v29, v45
  v_mul_f32 v30, v30, v45
  v_mul_f32 v31, v31, v45
  v_mul_f32 v32, v32, v45
  v_mul_f32 v33, v33, v45
  v_mul_f32 v34, v34, v45
  v_mul_f32 v35, v35, v45
  v_mul_f32 v36, v36, v45
  v_mul_f32 v37, v37, v45
  v_mul_f32 v38, v38, v45
  v_mul_f32 v39, v39, v45
  v_cvt_pk_bf16_f32 v24, v24, v24
  v_cvt_pk_bf16_f32 v25, v25, v25
  v_cvt_pk_bf16_f32 v26, v26, v26
  v_cvt_pk_bf16_f32 v27, v27, v27
  v_cvt_pk_bf16_f32 v28, v28, v28
  v_cvt_pk_bf16_f32 v29, v29, v29
  v_cvt_pk_bf16_f32 v30, v30, v30
  v_cvt_pk_bf16_f32 v31, v31, v31
  v_cvt_pk_bf16_f32 v32, v32, v32
  v_cvt_pk_bf16_f32 v33, v33, v33
  v_cvt_pk_bf16_f32 v34, v34, v34
  v_cvt_pk_bf16_f32 v35, v35, v35
  v_cvt_pk_bf16_f32 v36, v36, v36
  v_cvt_pk_bf16_f32 v37, v37, v37
  v_cvt_pk_bf16_f32 v38, v38, v38
  v_cvt_pk_bf16_f32 v39, v39, v39
  ds_write_b128 v149, v[24:27] offset:0
  ds_write_b128 v149, v[28:31] offset:1024
  ds_write_b128 v149, v[32:35] offset:2048
  ds_write_b128 v149, v[36:39] offset:3072
  s_mov_b64 exec, 1
  ds_add_u32 v147, v148 offset:16
  s_mov_b64 exec, -1
  s_mov_b32 s78, 1000000
L_f6:
  ds_read_b32 v9, v147 offset:8
  s_sub_u32 s78, s78, 1
  s_cbranch_scc1 L_f6_x
  s_waitcnt lgkmcnt(0)
  v_readfirstlane_b32 s63, v9
  s_nop 0
  s_cmp_ge_u32 s63, 4
  s_cbranch_scc1 L_f6_x
  s_sleep 8
  s_branch L_f6
L_f6_x:
  s_waitcnt lgkmcnt(0)
  ds_read_b128 v[24:27], v149 offset:8192
  ds_read_b128 v[28:31], v149 offset:9216
  ds_read_b128 v[32:35], v149 offset:10240
  ds_read_b128 v[36:39], v149 offset:11264
  s_waitcnt lgkmcnt(0)
  v_max3_f32 v44, v24, v25, v26
  v_max3_f32 v44, v44, v27, v28
  v_max3_f32 v44, v44, v29, v30
  v_max3_f32 v44, v44, v31, v32
  v_max3_f32 v44, v44, v33, v34
  v_max3_f32 v44, v44, v35, v36
  v_max3_f32 v44, v44, v37, v38
  v_max_f32 v44, v44, v39
  s_nop 1
  v_max_f32_dpp v44, v44, v44 quad_perm:[1,0,3,2] row_mask:0xf bank_mask:0xf
  s_nop 1
  v_max_f32_dpp v44, v44, v44 quad_perm:[2,3,0,1] row_mask:0xf bank_mask:0xf
  s_nop 1
  v_max_f32_dpp v44, v44, v44 row_half_mirror row_mask:0xf bank_mask:0xf
  s_nop 1
  v_max_f32_dpp v44, v44, v44 row_mirror row_mask:0xf bank_mask:0xf
  v_mov_b32 v11, v44
  s_nop 1
  v_permlane16_swap_b32 v44, v11
  v_max_f32 v44, v44, v11
  v_mov_b32 v11, v44
  s_nop 1
  v_permlane32_swap_b32 v44, v11
  v_max_f32 v44, v44, v11
  v_sub_f32 v24, v24, v44
  v_sub_f32 v25, v25, v44
  v_sub_f32 v26, v26, v44
  v_sub_f32 v27, v27, v44
  v_sub_f32 v28, v28, v44
  v_sub_f32 v29, v29, v44
  v_sub_f32 v30, v30, v44
  v_sub_f32 v31, v31, v44
  v_sub_f32 v32, v32, v44
  v_sub_f32 v33, v33, v44
  v_sub_f32 v34, v34, v44
  v_sub_f32 v35, v35, v44
  v_sub_f32 v36, v36, v44
  v_sub_f32 v37, v37, v44
  v_sub_f32 v38, v38, v44
  v_sub_f32 v39, v39, v44
  v_mul_f32 v24, s60, v24
  v_mul_f32 v25, s60, v25
  v_mul_f32 v26, s60, v26
  v_mul_f32 v27, s60, v27
  v_mul_f32 v28, s60, v28
  v_mul_f32 v29, s60, v29
  v_mul_f32 v30, s60, v30
  v_mul_f32 v31, s60, v31
  v_mul_f32 v32, s60, v32
  v_mul_f32 v33, s60, v33
  v_mul_f32 v34, s60, v34
  v_mul_f32 v35, s60, v35
  v_mul_f32 v36, s60, v36
  v_mul_f32 v37, s60, v37
  v_mul_f32 v38, s60, v38
  v_mul_f32 v39, s60, v39
  v_exp_f32 v24, v24
  v_exp_f32 v25, v25
  v_exp_f32 v26, v26
  v_exp_f32 v27, v27
  v_exp_f32 v28, v28
  v_exp_f32 v29, v29
  v_exp_f32 v30, v30
  v_exp_f32 v31, v31
  v_exp_f32 v32, v32
  v_exp_f32 v33, v33
  v_exp_f32 v34, v34
  v_exp_f32 v35, v35
  v_exp_f32 v36, v36
  v_exp_f32 v37, v37
  v_exp_f32 v38, v38
  v_exp_f32 v39, v39
  v_add_f32 v45, v24, v25
  v_add_f32 v45, v45, v26
  v_add_f32 v45, v45, v27
  v_add_f32 v45, v45, v28
  v_add_f32 v45, v45, v29
  v_add_f32 v45, v45, v30
  v_add_f32 v45, v45, v31
  v_add_f32 v45, v45, v32
  v_add_f32 v45, v45, v33
  v_add_f32 v45, v45, v34
  v_add_f32 v45, v45, v35
  v_add_f32 v45, v45, v36
  v_add_f32 v45, v45, v37
  v_add_f32 v45, v45, v38
  v_add_f32 v45, v45, v39
  s_nop 1
  v_add_f32_dpp v45, v45, v45 quad_perm:[1,0,3,2] row_mask:0xf bank_mask:0xf
  s_nop 1
  v_add_f32_dpp v45, v45, v45 quad_perm:[2,3,0,1] row_mask:0xf bank_mask:0xf
  s_nop 1
  v_add_f32_dpp v45, v45, v45 row_half_mirror row_mask:0xf bank_mask:0xf
  s_nop 1
  v_add_f32_dpp v45, v45, v45 row_mirror row_mask:0xf bank_mask:0xf
  v_mov_b32 v11, v45
  s_nop 1
  v_permlane16_swap_b32 v45, v11
  v_add_f32 v45, v45, v11
  v_mov_b32 v11, v45
  s_nop 1
  v_permlane32_swap_b32 v45, v11
  v_add_f32 v45, v45, v11
  s_add_u32 s63, s65, 32768
  s_mov_b64 exec, 15
  buffer_store_dwordx4 v[44:47], v2, s[12:15], s63 offen sc1
  s_mov_b64 exec, -1
  s_add_u32 s66, s64, 16384
  s_mov_b32 s78, 1000000
L_p7:
  buffer_load_dwordx4 v[40:43], v150, s[12:15], s66 offen sc1
  s_sub_u32 s78, s78, 1
  s_cbranch_scc1 L_p7_x
  s_waitcnt vmcnt(0)
  v_cmp_ne_u32 vcc, s46, v43
  s_cbranch_vccz L_p7_x
  s_sleep 32
  s_branch L_p7
L_p7_x:
  s_waitcnt vmcnt(0)
  ds_read_b128 v[24:27], v149 offset:4096
  ds_read_b128 v[28:31], v149 offset:5120
  ds_read_b128 v[32:35], v149 offset:6144
  ds_read_b128 v[36:39], v149 offset:7168
  s_waitcnt lgkmcnt(0)
  v_mov_b32 v44, v40
  s_nop 1
  v_max_f32_dpp v44, v44, v44 quad_perm:[1,0,3,2] row_mask:0xf bank_mask:0xf
  s_nop 1
  v_max_f32_dpp v44, v44, v44 quad_perm:[2,3,0,1] row_mask:0xf bank_mask:0xf
  s_nop 1
  v_max_f32_dpp v44, v44, v44 row_half_mirror row_mask:0xf bank_mask:0xf
  s_nop 1
  v_max_f32_dpp v44, v44, v44 row_mirror row_mask:0xf bank_mask:0xf
  v_mov_b32 v11, v44
  s_nop 1
  v_permlane16_swap_b32 v44, v11
  v_max_f32 v44, v44, v11
  v_mov_b32 v11, v44
  s_nop 1
  v_permlane32_swap_b32 v44, v11
  v_max_f32 v44, v44, v11
  v_sub_f32 v40, v40, v44
  v_mul_f32 v40, s60, v40
  v_exp_f32 v40, v40
  s_nop 0
  v_mul_f32 v45, v40, v41
  s_nop 1
  v_add_f32_dpp v45, v45, v45 quad_perm:[1,0,3,2] row_mask:0xf bank_mask:0xf
  s_nop 1
  v_add_f32_dpp v45, v45, v45 quad_perm:[2,3,0,1] row_mask:0xf bank_mask:0xf
  s_nop 1
  v_add_f32_dpp v45, v45, v45 row_half_mirror row_mask:0xf bank_mask:0xf
  s_nop 1
  v_add_f32_dpp v45, v45, v45 row_mirror row_mask:0xf bank_mask:0xf
  v_mov_b32 v11, v45
  s_nop 1
  v_permlane16_swap_b32 v45, v11
  v_add_f32 v45, v45, v11
  v_mov_b32 v11, v45
  s_nop 1
  v_permlane32_swap_b32 v45, v11
  v_add_f32 v45, v45, v11
  v_mul_f32 v45, 0.5, v45
  v_rcp_f32 v45, v45
  v_sub_f32 v24, v24, v44
  v_sub_f32 v25, v25, v44
  v_sub_f32 v26, v26, v44
  v_sub_f32 v27, v27, v44
  v_sub_f32 v28, v28, v44
  v_sub_f32 v29, v29, v44
  v_sub_f32 v30, v30, v44
  v_sub_f32 v31, v31, v44
  v_sub_f32 v32, v32, v44
  v_sub_f32 v33, v33, v44
  v_sub_f32 v34, v34, v44
  v_sub_f32 v35, v35, v44
  v_sub_f32 v36, v36, v44
  v_sub_f32 v37, v37, v44
  v_sub_f32 v38, v38, v44
  v_sub_f32 v39, v39, v44
  v_mul_f32 v24, s60, v24
  v_mul_f32 v25, s60, v25
  v_mul_f32 v26, s60, v26
  v_mul_f32 v27, s60, v27
  v_mul_f32 v28, s60, v28
  v_mul_f32 v29, s60, v29
  v_mul_f32 v30, s60, v30
  v_mul_f32 v31, s60, v31
  v_mul_f32 v32, s60, v32
  v_mul_f32 v33, s60, v33
  v_mul_f32 v34, s60, v34
  v_mul_f32 v35, s60, v35
  v_mul_f32 v36, s60, v36
  v_mul_f32 v37, s60, v37
  v_mul_f32 v38, s60, v38
  v_mul_f32 v39, s60, v39
  v_exp_f32 v24, v24
  v_exp_f32 v25, v25
  v_exp_f32 v26, v26
  v_exp_f32 v27, v27
  v_exp_f32 v28, v28
  v_exp_f32 v29, v29
  v_exp_f32 v30, v30
  v_exp_f32 v31, v31
  v_exp_f32 v32, v32
  v_exp_f32 v33, v33
  v_exp_f32 v34, v34
  v_exp_f32 v35, v35
  v_exp_f32 v36, v36
  v_exp_f32 v37, v37
  v_exp_f32 v38, v38
  v_exp_f32 v39, v39
  v_mul_f32 v24, v24, v45
  v_mul_f32 v25, v25, v45
  v_mul_f32 v26, v26, v45
  v_mul_f32 v27, v27, v45
  v_mul_f32 v28, v28, v45
  v_mul_f32 v29, v29, v45
  v_mul_f32 v30, v30, v45
  v_mul_f32 v31, v31, v45
  v_mul_f32 v32, v32, v45
  v_mul_f32 v33, v33, v45
  v_mul_f32 v34, v34, v45
  v_mul_f32 v35, v35, v45
  v_mul_f32 v36, v36, v45
  v_mul_f32 v37, v37, v45
  v_mul_f32 v38, v38, v45
  v_mul_f32 v39, v39, v45
  v_cvt_pk_bf16_f32 v24, v24, v24
  v_cvt_pk_bf16_f32 v25, v25, v25
  v_cvt_pk_bf16_f32 v26, v26, v26
  v_cvt_pk_bf16_f32 v27, v27, v27
  v_cvt_pk_bf16_f32 v28, v28, v28
  v_cvt_pk_bf16_f32 v29, v29, v29
  v_cvt_pk_bf16_f32 v30, v30, v30
  v_cvt_pk_bf16_f32 v31, v31, v31
  v_cvt_pk_bf16_f32 v32, v32, v32
  v_cvt_pk_bf16_f32 v33, v33, v33
  v_cvt_pk_bf16_f32 v34, v34, v34
  v_cvt_pk_bf16_f32 v35, v35, v35
  v_cvt_pk_bf16_f32 v36, v36, v36
  v_cvt_pk_bf16_f32 v37, v37, v37
  v_cvt_pk_bf16_f32 v38, v38, v38
  v_cvt_pk_bf16_f32 v39, v39, v39
  ds_write_b128 v149, v[24:27] offset:4096
  ds_write_b128 v149, v[28:31] offset:5120
  ds_write_b128 v149, v[32:35] offset:6144
  ds_write_b128 v149, v[36:39] offset:7168
  s_mov_b64 exec, 1
  ds_add_u32 v147, v148 offset:20
  s_mov_b64 exec, -1
  s_mov_b32 s78, 1000000
L_f8:
  ds_read_b32 v9, v147 offset:12
  s_sub_u32 s78, s78, 1
  s_cbranch_scc1 L_f8_x
  s_waitcnt lgkmcnt(0)
  v_readfirstlane_b32 s63, v9
  s_nop 0
  s_cmp_ge_u32 s63, 4
  s_cbranch_scc1 L_f8_x
  s_sleep 8
  s_branch L_f8
L_f8_x:
  s_waitcnt lgkmcnt(0)
  ds_read_b128 v[24:27], v149 offset:12288
  ds_read_b128 v[28:31], v149 offset:13312
  ds_read_b128 v[32:35], v149 offset:14336
  ds_read_b128 v[36:39], v149 offset:15360
  s_waitcnt lgkmcnt(0)
  v_max3_f32 v44, v24, v25, v26
  v_max3_f32 v44, v44, v27, v28
  v_max3_f32 v44, v44, v29, v30
  v_max3_f32 v44, v44, v31, v32
  v_max3_f32 v44, v44, v33, v34
  v_max3_f32 v44, v44, v35, v36
  v_max3_f32 v44, v44, v37, v38
  v_max_f32 v44, v44, v39
  s_nop 1
  v_max_f32_dpp v44, v44, v44 quad_perm:[1,0,3,2] row_mask:0xf bank_mask:0xf
  s_nop 1
  v_max_f32_dpp v44, v44, v44 quad_perm:[2,3,0,1] row_mask:0xf bank_mask:0xf
  s_nop 1
  v_max_f32_dpp v44, v44, v44 row_half_mirror row_mask:0xf bank_mask:0xf
  s_nop 1
  v_max_f32_dpp v44, v44, v44 row_mirror row_mask:0xf bank_mask:0xf
  v_mov_b32 v11, v44
  s_nop 1
  v_permlane16_swap_b32 v44, v11
  v_max_f32 v44, v44, v11
  v_mov_b32 v11, v44
  s_nop 1
  v_permlane32_swap_b32 v44, v11
  v_max_f32 v44, v44, v11
  v_sub_f32 v24, v24, v44
  v_sub_f32 v25, v25, v44
  v_sub_f32 v26, v26, v44
  v_sub_f32 v27, v27, v44
  v_sub_f32 v28, v28, v44
  v_sub_f32 v29, v29, v44
  v_sub_f32 v30, v30, v44
  v_sub_f32 v31, v31, v44
  v_sub_f32 v32, v32, v44
  v_sub_f32 v33, v33, v44
  v_sub_f32 v34, v34, v44
  v_sub_f32 v35, v35, v44
  v_sub_f32 v36, v36, v44
  v_sub_f32 v37, v37, v44
  v_sub_f32 v38, v38, v44
  v_sub_f32 v39, v39, v44
  v_mul_f32 v24, s60, v24
  v_mul_f32 v25, s60, v25
  v_mul_f32 v26, s60, v26
  v_mul_f32 v27, s60, v27
  v_mul_f32 v28, s60, v28
  v_mul_f32 v29, s60, v29
  v_mul_f32 v30, s60, v30
  v_mul_f32 v31, s60, v31
  v_mul_f32 v32, s60, v32
  v_mul_f32 v33, s60, v33
  v_mul_f32 v34, s60, v34
  v_mul_f32 v35, s60, v35
  v_mul_f32 v36, s60, v36
  v_mul_f32 v37, s60, v37
  v_mul_f32 v38, s60, v38
  v_mul_f32 v39, s60, v39
  v_exp_f32 v24, v24
  v_exp_f32 v25, v25
  v_exp_f32 v26, v26
  v_exp_f32 v27, v27
  v_exp_f32 v28, v28
  v_exp_f32 v29, v29
  v_exp_f32 v30, v30
  v_exp_f32 v31, v31
  v_exp_f32 v32, v32
  v_exp_f32 v33, v33
  v_exp_f32 v34, v34
  v_exp_f32 v35, v35
  v_exp_f32 v36, v36
  v_exp_f32 v37, v37
  v_exp_f32 v38, v38
  v_exp_f32 v39, v39
  v_add_f32 v45, v24, v25
  v_add_f32 v45, v45, v26
  v_add_f32 v45, v45, v27
  v_add_f32 v45, v45, v28
  v_add_f32 v45, v45, v29
  v_add_f32 v45, v45, v30
  v_add_f32 v45, v45, v31
  v_add_f32 v45, v45, v32
  v_add_f32 v45, v45, v33
  v_add_f32 v45, v45, v34
  v_add_f32 v45, v45, v35
  v_add_f32 v45, v45, v36
  v_add_f32 v45, v45, v37
  v_add_f32 v45, v45, v38
  v_add_f32 v45, v45, v39
  s_nop 1
  v_add_f32_dpp v45, v45, v45 quad_perm:[1,0,3,2] row_mask:0xf bank_mask:0xf
  s_nop 1
  v_add_f32_dpp v45, v45, v45 quad_perm:[2,3,0,1] row_mask:0xf bank_mask:0xf
  s_nop 1
  v_add_f32_dpp v45, v45, v45 row_half_mirror row_mask:0xf bank_mask:0xf
  s_nop 1
  v_add_f32_dpp v45, v45, v45 row_mirror row_mask:0xf bank_mask:0xf
  v_mov_b32 v11, v45
  s_nop 1
  v_permlane16_swap_b32 v45, v11
  v_add_f32 v45, v45, v11
  v_mov_b32 v11, v45
  s_nop 1
  v_permlane32_swap_b32 v45, v11
  v_add_f32 v45, v45, v11
  s_lshl_b32 s65, s96, 5
  s_add_u32 s65, s65, s97
  s_lshl_b32 s65, s65, 6
  s_add_u32 s65, s65, 589824
  s_add_u32 s63, s65, 49152
  s_mov_b64 exec, 15
  buffer_store_dwordx4 v[44:47], v2, s[12:15], s63 offen sc1
  s_mov_b64 exec, -1
  s_add_u32 s66, s64, 32768
  s_mov_b32 s78, 1000000
L_p9:
  buffer_load_dwordx4 v[40:43], v150, s[12:15], s66 offen sc1
  s_sub_u32 s78, s78, 1
  s_cbranch_scc1 L_p9_x
  s_waitcnt vmcnt(0)
  v_cmp_ne_u32 vcc, s46, v43
  s_cbranch_vccz L_p9_x
  s_sleep 32
  s_branch L_p9
L_p9_x:
  s_waitcnt vmcnt(0)
  ds_read_b128 v[24:27], v149 offset:8192
  ds_read_b128 v[28:31], v149 offset:9216
  ds_read_b128 v[32:35], v149 offset:10240
  ds_read_b128 v[36:39], v149 offset:11264
  s_waitcnt lgkmcnt(0)
  v_mov_b32 v44, v40
  s_nop 1
  v_max_f32_dpp v44, v44, v44 quad_perm:[1,0,3,2] row_mask:0xf bank_mask:0xf
  s_nop 1
  v_max_f32_dpp v44, v44, v44 quad_perm:[2,3,0,1] row_mask:0xf bank_mask:0xf
  s_nop 1
  v_max_f32_dpp v44, v44, v44 row_half_mirror row_mask:0xf bank_mask:0xf
  s_nop 1
  v_max_f32_dpp v44, v44, v44 row_mirror row_mask:0xf bank_mask:0xf
  v_mov_b32 v11, v44
  s_nop 1
  v_permlane16_swap_b32 v44, v11
  v_max_f32 v44, v44, v11
  v_mov_b32 v11, v44
  s_nop 1
  v_permlane32_swap_b32 v44, v11
  v_max_f32 v44, v44, v11
  v_sub_f32 v40, v40, v44
  v_mul_f32 v40, s60, v40
  v_exp_f32 v40, v40
  s_nop 0
  v_mul_f32 v45, v40, v41
  s_nop 1
  v_add_f32_dpp v45, v45, v45 quad_perm:[1,0,3,2] row_mask:0xf bank_mask:0xf
  s_nop 1
  v_add_f32_dpp v45, v45, v45 quad_perm:[2,3,0,1] row_mask:0xf bank_mask:0xf
  s_nop 1
  v_add_f32_dpp v45, v45, v45 row_half_mirror row_mask:0xf bank_mask:0xf
  s_nop 1
  v_add_f32_dpp v45, v45, v45 row_mirror row_mask:0xf bank_mask:0xf
  v_mov_b32 v11, v45
  s_nop 1
  v_permlane16_swap_b32 v45, v11
  v_add_f32 v45, v45, v11
  v_mov_b32 v11, v45
  s_nop 1
  v_permlane32_swap_b32 v45, v11
  v_add_f32 v45, v45, v11
  v_mul_f32 v45, 0.5, v45
  v_rcp_f32 v45, v45
  v_sub_f32 v24, v24, v44
  v_sub_f32 v25, v25, v44
  v_sub_f32 v26, v26, v44
  v_sub_f32 v27, v27, v44
  v_sub_f32 v28, v28, v44
  v_sub_f32 v29, v29, v44
  v_sub_f32 v30, v30, v44
  v_sub_f32 v31, v31, v44
  v_sub_f32 v32, v32, v44
  v_sub_f32 v33, v33, v44
  v_sub_f32 v34, v34, v44
  v_sub_f32 v35, v35, v44
  v_sub_f32 v36, v36, v44
  v_sub_f32 v37, v37, v44
  v_sub_f32 v38, v38, v44
  v_sub_f32 v39, v39, v44
  v_mul_f32 v24, s60, v24
  v_mul_f32 v25, s60, v25
  v_mul_f32 v26, s60, v26
  v_mul_f32 v27, s60, v27
  v_mul_f32 v28, s60, v28
  v_mul_f32 v29, s60, v29
  v_mul_f32 v30, s60, v30
  v_mul_f32 v31, s60, v31
  v_mul_f32 v32, s60, v32
  v_mul_f32 v33, s60, v33
  v_mul_f32 v34, s60, v34
  v_mul_f32 v35, s60, v35
  v_mul_f32 v36, s60, v36
  v_mul_f32 v37, s60, v37
  v_mul_f32 v38, s60, v38
  v_mul_f32 v39, s60, v39
  v_exp_f32 v24, v24
  v_exp_f32 v25, v25
  v_exp_f32 v26, v26
  v_exp_f32 v27, v27
  v_exp_f32 v28, v28
  v_exp_f32 v29, v29
  v_exp_f32 v30, v30
  v_exp_f32 v31, v31
  v_exp_f32 v32, v32
  v_exp_f32 v33, v33
  v_exp_f32 v34, v34
  v_exp_f32 v35, v35
  v_exp_f32 v36, v36
  v_exp_f32 v37, v37
  v_exp_f32 v38, v38
  v_exp_f32 v39, v39
  v_mul_f32 v24, v24, v45
  v_mul_f32 v25, v25, v45
  v_mul_f32 v26, v26, v45
  v_mul_f32 v27, v27, v45
  v_mul_f32 v28, v28, v45
  v_mul_f32 v29, v29, v45
  v_mul_f32 v30, v30, v45
  v_mul_f32 v31, v31, v45
  v_mul_f32 v32, v32, v45
  v_mul_f32 v33, v33, v45
  v_mul_f32 v34, v34, v45
  v_mul_f32 v35, v35, v45
  v_mul_f32 v36, v36, v45
  v_mul_f32 v37, v37, v45
  v_mul_f32 v38, v38, v45
  v_mul_f32 v39, v39, v45
  v_cvt_pk_bf16_f32 v24, v24, v24
  v_cvt_pk_bf16_f32 v25, v25, v25
  v_cvt_pk_bf16_f32 v26, v26, v26
  v_cvt_pk_bf16_f32 v27, v27, v27
  v_cvt_pk_bf16_f32 v28, v28, v28
  v_cvt_pk_bf16_f32 v29, v29, v29
  v_cvt_pk_bf16_f32 v30, v30, v30
  v_cvt_pk_bf16_f32 v31, v31, v31
  v_cvt_pk_bf16_f32 v32, v32, v32
  v_cvt_pk_bf16_f32 v33, v33, v33
  v_cvt_pk_bf16_f32 v34, v34, v34
  v_cvt_pk_bf16_f32 v35, v35, v35
  v_cvt_pk_bf16_f32 v36, v36, v36
  v_cvt_pk_bf16_f32 v37, v37, v37
  v_cvt_pk_bf16_f32 v38, v38, v38
  v_cvt_pk_bf16_f32 v39, v39, v39
  ds_write_b128 v149, v[24:27] offset:8192
  ds_write_b128 v149, v[28:31] offset:9216
  ds_write_b128 v149, v[32:35] offset:10240
  ds_write_b128 v149, v[36:39] offset:11264
  s_mov_b64 exec, 1
  ds_add_u32 v147, v148 offset:24
  s_mov_b64 exec, -1
  v_mul_u32_u24 v157, 12, v0
  v_add_u32 v155, 49152, v157
  v_add_u32 v157, 24576, v157
  v_add_u32 v158, 4, v157
  v_add_u32 v159, 8, v157
  v_mov_b32 v143, s46
  s_lshl_b32 s74, s48, 5
  s_add_u32 s74, s74, s47
  s_lshl_b32 s74, s74, 10
  s_add_u32 s74, s74, 1048576
  v_lshrrev_b32 v154, 4, v0
  v_lshlrev_b32 v154, 10, v154
  v_and_b32 v10, 15, v0
  v_lshl_add_u32 v154, v10, 4, v154
  s_mov_b32 s78, 1000000
L_f10:
  ds_read_b32 v9, v147 offset:32
  s_sub_u32 s78, s78, 1
  s_cbranch_scc1 L_f10_x
  s_waitcnt lgkmcnt(0)
  v_readfirstlane_b32 s63, v9
  s_nop 0
  s_cmp_ge_u32 s63, 4
  s_cbranch_scc1 L_f10_x
  s_sleep 8
  s_branch L_f10
L_f10_x:
  s_waitcnt lgkmcnt(0)
  ds_read2st64_b32 v[112:113], v157 offset0:0 offset1:3
  ds_read2st64_b32 v[114:115], v157 offset0:6 offset1:9
  ds_read2st64_b32 v[116:117], v157 offset0:12 offset1:15
  ds_read2st64_b32 v[118:119], v157 offset0:18 offset1:21
  ds_read2st64_b32 v[120:121], v158 offset0:0 offset1:3
  ds_read2st64_b32 v[122:123], v158 offset0:6 offset1:9
  ds_read2st64_b32 v[124:125], v158 offset0:12 offset1:15
  ds_read2st64_b32 v[126:127], v158 offset0:18 offset1:21
  ds_read2st64_b32 v[128:129], v159 offset0:0 offset1:3
  ds_read2st64_b32 v[130:131], v159 offset0:6 offset1:9
  ds_read2st64_b32 v[132:133], v159 offset0:12 offset1:15
  ds_read2st64_b32 v[134:135], v159 offset0:18 offset1:21
  s_waitcnt lgkmcnt(8)
  v_add_f32 v112, v112, v113
  v_add_f32 v114, v114, v115
  v_add_f32 v116, v116, v117
  v_add_f32 v118, v118, v119
  v_add_f32 v112, v112, v114
  v_add_f32 v116, v116, v118
  v_add_f32 v140, v112, v116
  s_waitcnt lgkmcnt(4)
  v_add_f32 v120, v120, v121
  v_add_f32 v122, v122, v123
  v_add_f32 v124, v124, v125
  v_add_f32 v126, v126, v127
  v_add_f32 v120, v120, v122
  v_add_f32 v124, v124, v126
  v_add_f32 v141, v120, v124
  s_waitcnt lgkmcnt(0)
  v_add_f32 v128, v128, v129
  v_add_f32 v130, v130, v131
  v_add_f32 v132, v132, v133
  v_add_f32 v134, v134, v135
  v_add_f32 v128, v128, v130
  v_add_f32 v132, v132, v134
  v_add_f32 v142, v128, v132
  s_getreg_b32 s63, hwreg(HW_REG_XCC_ID)
  s_cmp_eq_u32 s63, s98
  s_cbranch_scc1 L_w11
  buffer_store_dwordx4 v[140:143], v2, s[12:15], s74 offen sc1
  s_branch L_w11_x
L_w11:
  buffer_store_dwordx4 v[140:143], v2, s[12:15], s74 offen
L_w11_x:
  v_add_u32 v157, 6144, v157
  v_add_u32 v158, 6144, v158
  v_add_u32 v159, 6144, v159
  s_add_u32 s74, s74, 0x40000
  s_lshl_b32 s64, s96, 11
  s_add_u32 s64, s64, 589824
  s_add_u32 s66, s64, 49152
  s_mov_b32 s78, 1000000
L_p12:
  buffer_load_dwordx4 v[40:43], v150, s[12:15], s66 offen sc1
  s_sub_u32 s78, s78, 1
  s_cbranch_scc1 L_p12_x
  s_waitcnt vmcnt(0)
  v_cmp_ne_u32 vcc, s46, v43
  s_cbranch_vccz L_p12_x
  s_sleep 32
  s_branch L_p12
L_p12_x:
  s_waitcnt vmcnt(0)
  ds_read_b128 v[24:27], v149 offset:12288
  ds_read_b128 v[28:31], v149 offset:13312
  ds_read_b128 v[32:35], v149 offset:14336
  ds_read_b128 v[36:39], v149 offset:15360
  s_waitcnt lgkmcnt(0)
  v_mov_b32 v44, v40
  s_nop 1
  v_max_f32_dpp v44, v44, v44 quad_perm:[1,0,3,2] row_mask:0xf bank_mask:0xf
  s_nop 1
  v_max_f32_dpp v44, v44, v44 quad_perm:[2,3,0,1] row_mask:0xf bank_mask:0xf
  s_nop 1
  v_max_f32_dpp v44, v44, v44 row_half_mirror row_mask:0xf bank_mask:0xf
  s_nop 1
  v_max_f32_dpp v44, v44, v44 row_mirror row_mask:0xf bank_mask:0xf
  v_mov_b32 v11, v44
  s_nop 1
  v_permlane16_swap_b32 v44, v11
  v_max_f32 v44, v44, v11
  v_mov_b32 v11, v44
  s_nop 1
  v_permlane32_swap_b32 v44, v11
  v_max_f32 v44, v44, v11
  v_sub_f32 v40, v40, v44
  v_mul_f32 v40, s60, v40
  v_exp_f32 v40, v40
  s_nop 0
  v_mul_f32 v45, v40, v41
  s_nop 1
  v_add_f32_dpp v45, v45, v45 quad_perm:[1,0,3,2] row_mask:0xf bank_mask:0xf
  s_nop 1
  v_add_f32_dpp v45, v45, v45 quad_perm:[2,3,0,1] row_mask:0xf bank_mask:0xf
  s_nop 1
  v_add_f32_dpp v45, v45, v45 row_half_mirror row_mask:0xf bank_mask:0xf
  s_nop 1
  v_add_f32_dpp v45, v45, v45 row_mirror row_mask:0xf bank_mask:0xf
  v_mov_b32 v11, v45
  s_nop 1
  v_permlane16_swap_b32 v45, v11
  v_add_f32 v45, v45, v11
  v_mov_b32 v11, v45
  s_nop 1
  v_permlane32_swap_b32 v45, v11
  v_add_f32 v45, v45, v11
  v_mul_f32 v45, 0.5, v45
  v_rcp_f32 v45, v45
  v_sub_f32 v24, v24, v44
  v_sub_f32 v25, v25, v44
  v_sub_f32 v26, v26, v44
  v_sub_f32 v27, v27, v44
  v_sub_f32 v28, v28, v44
  v_sub_f32 v29, v29, v44
  v_sub_f32 v30, v30, v44
  v_sub_f32 v31, v31, v44
  v_sub_f32 v32, v32, v44
  v_sub_f32 v33, v33, v44
  v_sub_f32 v34, v34, v44
  v_sub_f32 v35, v35, v44
  v_sub_f32 v36, v36, v44
  v_sub_f32 v37, v37, v44
  v_sub_f32 v38, v38, v44
  v_sub_f32 v39, v39, v44
  v_mul_f32 v24, s60, v24
  v_mul_f32 v25, s60, v25
  v_mul_f32 v26, s60, v26
  v_mul_f32 v27, s60, v27
  v_mul_f32 v28, s60, v28
  v_mul_f32 v29, s60, v29
  v_mul_f32 v30, s60, v30
  v_mul_f32 v31, s60, v31
  v_mul_f32 v32, s60, v32
  v_mul_f32 v33, s60, v33
  v_mul_f32 v34, s60, v34
  v_mul_f32 v35, s60, v35
  v_mul_f32 v36, s60, v36
  v_mul_f32 v37, s60, v37
  v_mul_f32 v38, s60, v38
  v_mul_f32 v39, s60, v39
  v_exp_f32 v24, v24
  v_exp_f32 v25, v25
  v_exp_f32 v26, v26
  v_exp_f32 v27, v27
  v_exp_f32 v28, v28
  v_exp_f32 v29, v29
  v_exp_f32 v30, v30
  v_exp_f32 v31, v31
  v_exp_f32 v32, v32
  v_exp_f32 v33, v33
  v_exp_f32 v34, v34
  v_exp_f32 v35, v35
  v_exp_f32 v36, v36
  v_exp_f32 v37, v37
  v_exp_f32 v38, v38
  v_exp_f32 v39, v39
  v_mul_f32 v24, v24, v45
  v_mul_f32 v25, v25, v45
  v_mul_f32 v26, v26, v45
  v_mul_f32 v27, v27, v45
  v_mul_f32 v28, v28, v45
  v_mul_f32 v29, v29, v45
  v_mul_f32 v30, v30, v45
  v_mul_f32 v31, v31, v45
  v_mul_f32 v32, v32, v45
  v_mul_f32 v33, v33, v45
  v_mul_f32 v34, v34, v45
  v_mul_f32 v35, v35, v45
  v_mul_f32 v36, v36, v45
  v_mul_f32 v37, v37, v45
  v_mul_f32 v38, v38, v45
  v_mul_f32 v39, v39, v45
  v_cvt_pk_bf16_f32 v24, v24, v24
  v_cvt_pk_bf16_f32 v25, v25, v25
  v_cvt_pk_bf16_f32 v26, v26, v26
  v_cvt_pk_bf16_f32 v27, v27, v27
  v_cvt_pk_bf16_f32 v28, v28, v28
  v_cvt_pk_bf16_f32 v29, v29, v29
  v_cvt_pk_bf16_f32 v30, v30, v30
  v_cvt_pk_bf16_f32 v31, v31, v31
  v_cvt_pk_bf16_f32 v32, v32, v32
  v_cvt_pk_bf16_f32 v33, v33, v33
  v_cvt_pk_bf16_f32 v34, v34, v34
  v_cvt_pk_bf16_f32 v35, v35, v35
  v_cvt_pk_bf16_f32 v36, v36, v36
  v_cvt_pk_bf16_f32 v37, v37, v37
  v_cvt_pk_bf16_f32 v38, v38, v38
  v_cvt_pk_bf16_f32 v39, v39, v39
  ds_write_b128 v149, v[24:27] offset:12288
  ds_write_b128 v149, v[28:31] offset:13312
  ds_write_b128 v149, v[32:35] offset:14336
  ds_write_b128 v149, v[36:39] offset:15360
  s_mov_b64 exec, 1
  ds_add_u32 v147, v148 offset:28
  s_mov_b64 exec, -1
  s_lshl_b32 s63, s96, 5
  s_add_u32 s63, s63, s97
  s_lshl_b32 s66, s63, 11
  s_add_u32 s66, s66, 2097152
  s_lshl_b32 s63, s63, 6
  s_add_u32 s63, s63, 16384
  v_lshlrev_b32 v10, 3, v0
  v_bfi_b32 v32, s62, v33, v32
  v_bfi_b32 v33, s62, v35, v34
  buffer_store_dwordx2 v[32:33], v10, s[12:15], s66 offen offset:1024 sc1
  v_bfi_b32 v36, s62, v37, v36
  v_bfi_b32 v37, s62, v39, v38
  buffer_store_dwordx2 v[36:37], v10, s[12:15], s66 offen offset:1536 sc1
  s_waitcnt vmcnt(0)
  s_mov_b64 exec, 15
  buffer_store_dwordx4 v[44:47], v2, s[12:15], s63 offen sc1
  s_mov_b64 exec, -1
  s_mov_b32 s78, 1000000
L_f13:
  ds_read_b32 v9, v147 offset:36
  s_sub_u32 s78, s78, 1
  s_cbranch_scc1 L_f13_x
  s_waitcnt lgkmcnt(0)
  v_readfirstlane_b32 s63, v9
  s_nop 0
  s_cmp_ge_u32 s63, 4
  s_cbranch_scc1 L_f13_x
  s_sleep 8
  s_branch L_f13
L_f13_x:
  s_waitcnt lgkmcnt(0)
  ds_read2st64_b32 v[112:113], v157 offset0:0 offset1:3
  ds_read2st64_b32 v[114:115], v157 offset0:6 offset1:9
  ds_read2st64_b32 v[116:117], v157 offset0:12 offset1:15
  ds_read2st64_b32 v[118:119], v157 offset0:18 offset1:21
  ds_read2st64_b32 v[120:121], v158 offset0:0 offset1:3
  ds_read2st64_b32 v[122:123], v158 offset0:6 offset1:9
  ds_read2st64_b32 v[124:125], v158 offset0:12 offset1:15
  ds_read2st64_b32 v[126:127], v158 offset0:18 offset1:21
  ds_read2st64_b32 v[128:129], v159 offset0:0 offset1:3
  ds_read2st64_b32 v[130:131], v159 offset0:6 offset1:9
  ds_read2st64_b32 v[132:133], v159 offset0:12 offset1:15
  ds_read2st64_b32 v[134:135], v159 offset0:18 offset1:21
  s_waitcnt lgkmcnt(8)
  v_add_f32 v112, v112, v113
  v_add_f32 v114, v114, v115
  v_add_f32 v116, v116, v117
  v_add_f32 v118, v118, v119
  v_add_f32 v112, v112, v114
  v_add_f32 v116, v116, v118
  v_add_f32 v140, v112, v116
  s_waitcnt lgkmcnt(4)
  v_add_f32 v120, v120, v121
  v_add_f32 v122, v122, v123
  v_add_f32 v124, v124, v125
  v_add_f32 v126, v126, v127
  v_add_f32 v120, v120, v122
  v_add_f32 v124, v124, v126
  v_add_f32 v141, v120, v124
  s_waitcnt lgkmcnt(0)
  v_add_f32 v128, v128, v129
  v_add_f32 v130, v130, v131
  v_add_f32 v132, v132, v133
  v_add_f32 v134, v134, v135
  v_add_f32 v128, v128, v130
  v_add_f32 v132, v132, v134
  v_add_f32 v142, v128, v132
  s_getreg_b32 s63, hwreg(HW_REG_XCC_ID)
  s_cmp_eq_u32 s63, s98
  s_cbranch_scc1 L_w14
  buffer_store_dwordx4 v[140:143], v2, s[12:15], s74 offen sc1
  s_branch L_w14_x
L_w14:
  buffer_store_dwordx4 v[140:143], v2, s[12:15], s74 offen
L_w14_x:
  v_add_u32 v157, 6144, v157
  v_add_u32 v158, 6144, v158
  v_add_u32 v159, 6144, v159
  s_add_u32 s74, s74, 0x40000
  s_lshl_b32 s66, s96, 11
  s_add_u32 s66, s66, 16384
  v_and_b32 v153, 31, v0
  v_lshlrev_b32 v153, 6, v153
  s_mov_b32 s78, 1000000
L_p15:
  buffer_load_dwordx4 v[40:43], v153, s[12:15], s66 offen sc1
  s_sub_u32 s78, s78, 1
  s_cbranch_scc1 L_p15_x
  s_waitcnt vmcnt(0)
  v_cmp_ne_u32 vcc, s46, v43
  s_cbranch_vccz L_p15_x
  s_sleep 32
  s_branch L_p15
L_p15_x:
  s_waitcnt vmcnt(0)
  s_mov_b64 exec, 1
  ds_add_u32 v147, v148 offset:56
  s_mov_b64 exec, -1
  s_lshr_b32 s63, s47, 2
  s_cmp_lg_u32 s63, 0
  s_cbranch_scc1 L_c16
  s_and_b32 s73, s47, 3
  s_lshl_b32 s73, s73, 8
  s_lshl_b32 s66, s48, 15
  s_add_u32 s66, s66, s73
  s_add_u32 s66, s66, 1048576
  s_add_u32 s67, s66, 4096
  s_add_u32 s68, s66, 8192
  s_add_u32 s69, s66, 12288
  s_add_u32 s70, s66, 16384
  s_add_u32 s71, s66, 20480
  s_add_u32 s72, s66, 24576
  s_add_u32 s73, s66, 28672
  s_mov_b32 s78, 1000000
L_p17:
  buffer_load_dwordx4 v[112:115], v154, s[12:15], s66 offen sc1 nt
  buffer_load_dwordx4 v[116:119], v154, s[12:15], s67 offen sc1 nt
  buffer_load_dwordx4 v[120:123], v154, s[12:15], s68 offen sc1 nt
  buffer_load_dwordx4 v[124:127], v154, s[12:15], s69 offen sc1 nt
  buffer_load_dwordx4 v[128:131], v154, s[12:15], s70 offen sc1 nt
  buffer_load_dwordx4 v[132:135], v154, s[12:15], s71 offen sc1 nt
  buffer_load_dwordx4 v[136:139], v154, s[12:15], s72 offen sc1 nt
  buffer_load_dwordx4 v[140:143], v154, s[12:15], s73 offen sc1 nt
  s_sub_u32 s78, s78, 1
  s_cbranch_scc1 L_p17_x
  s_waitcnt vmcnt(0)
  v_min_u32 v10, v115, v143
  v_max_u32 v11, v115, v143
  v_min3_u32 v10, v10, v119, v123
  v_max3_u32 v11, v11, v119, v123
  v_min3_u32 v10, v10, v127, v131
  v_max3_u32 v11, v11, v127, v131
  v_min3_u32 v10, v10, v135, v139
  v_max3_u32 v11, v11, v135, v139
  v_cmp_ne_u32 vcc, s46, v10
  v_cmp_ne_u32 s[80:81], s46, v11
  s_nop 0
  s_or_b64 vcc, vcc, s[80:81]
  s_cbranch_vccz L_p17_x
  s_sleep 32
  s_branch L_p17
L_p17_x:
  s_waitcnt vmcnt(0)
  v_pk_add_f32 v[112:113], v[112:113], v[116:117]
  v_add_f32 v114, v114, v118
  v_pk_add_f32 v[120:121], v[120:121], v[124:125]
  v_add_f32 v122, v122, v126
  v_pk_add_f32 v[128:129], v[128:129], v[132:133]
  v_add_f32 v130, v130, v134
  v_pk_add_f32 v[136:137], v[136:137], v[140:141]
  v_add_f32 v138, v138, v142
  v_pk_add_f32 v[112:113], v[112:113], v[120:121]
  v_add_f32 v114, v114, v122
  v_pk_add_f32 v[128:129], v[128:129], v[136:137]
  v_add_f32 v130, v130, v138
  v_pk_add_f32 v[20:21], v[112:113], v[128:129]
  v_add_f32 v22, v114, v130
  v_mov_b32 v112, v20
  v_mov_b32 v113, v21
  v_mov_b32 v114, v22
  v_permlane16_swap_b32 v20, v112
  v_permlane16_swap_b32 v21, v113
  v_permlane16_swap_b32 v22, v114
  v_add_f32 v20, v20, v112
  v_add_f32 v21, v21, v113
  v_add_f32 v22, v22, v114
  v_mov_b32 v112, v20
  v_mov_b32 v113, v21
  v_mov_b32 v114, v22
  v_permlane32_swap_b32 v20, v112
  v_permlane32_swap_b32 v21, v113
  v_permlane32_swap_b32 v22, v114
  v_add_f32 v20, v20, v112
  v_add_f32 v21, v21, v113
  v_add_f32 v22, v22, v114
  v_cvt_pk_bf16_f32 v20, v20, v20
  v_cvt_pk_bf16_f32 v21, v21, v21
  v_cvt_pk_bf16_f32 v22, v22, v22
  s_and_b32 s73, s47, 3
  s_lshl_b32 s73, s73, 8
  s_lshl_b32 s63, s48, 10
  s_add_u32 s63, s63, s73
  s_add_u32 s63, s63, 32768
  v_mov_b32 v23, s46
  s_mov_b64 exec, 0xffff
  buffer_store_dwordx4 v[20:23], v2, s[12:15], s63 offen sc1
  s_mov_b64 exec, -1
  v_mov_b32 v143, s46
L_c16:
  s_mov_b32 s78, 1000000
L_f18:
  ds_read_b32 v9, v147 offset:40
  s_sub_u32 s78, s78, 1
  s_cbranch_scc1 L_f18_x
  s_waitcnt lgkmcnt(0)
  v_readfirstlane_b32 s63, v9
  s_nop 0
  s_cmp_ge_u32 s63, 4
  s_cbranch_scc1 L_f18_x
  s_sleep 8
  s_branch L_f18
L_f18_x:
  s_waitcnt lgkmcnt(0)
  s_lshl_b32 s73, s47, 8
  s_add_u32 s73, s73, 8192
  s_mov_b32 s78, 1000000
  v_mov_b32 v40, 1
  v_mov_b32 v41, 0
  s_mov_b64 exec, 1
  buffer_atomic_add_x2 v[40:41], v2, s[12:15], s73 offen sc0
  s_mov_b64 exec, -1
  ds_read2st64_b32 v[112:113], v157 offset0:0 offset1:3
  ds_read2st64_b32 v[114:115], v157 offset0:6 offset1:9
  ds_read2st64_b32 v[116:117], v157 offset0:12 offset1:15
  ds_read2st64_b32 v[118:119], v157 offset0:18 offset1:21
  ds_read2st64_b32 v[120:121], v158 offset0:0 offset1:3
  ds_read2st64_b32 v[122:123], v158 offset0:6 offset1:9
  ds_read2st64_b32 v[124:125], v158 offset0:12 offset1:15
  ds_read2st64_b32 v[126:127], v158 offset0:18 offset1:21
  ds_read2st64_b32 v[128:129], v159 offset0:0 offset1:3
  ds_read2st64_b32 v[130:131], v159 offset0:6 offset1:9
  ds_read2st64_b32 v[132:133], v159 offset0:12 offset1:15
  ds_read2st64_b32 v[134:135], v159 offset0:18 offset1:21
  s_waitcnt lgkmcnt(8)
  v_add_f32 v112, v112, v113
  v_add_f32 v114, v114, v115
  v_add_f32 v116, v116, v117
  v_add_f32 v118, v118, v119
  v_add_f32 v112, v112, v114
  v_add_f32 v116, v116, v118
  v_add_f32 v140, v112, v116
  s_waitcnt lgkmcnt(4)
  v_add_f32 v120, v120, v121
  v_add_f32 v122, v122, v123
  v_add_f32 v124, v124, v125
  v_add_f32 v126, v126, v127
  v_add_f32 v120, v120, v122
  v_add_f32 v124, v124, v126
  v_add_f32 v141, v120, v124
  s_waitcnt lgkmcnt(0)
  v_add_f32 v128, v128, v129
  v_add_f32 v130, v130, v131
  v_add_f32 v132, v132, v133
  v_add_f32 v134, v134, v135
  v_add_f32 v128, v128, v130
  v_add_f32 v132, v132, v134
  v_add_f32 v142, v128, v132
  s_getreg_b32 s63, hwreg(HW_REG_XCC_ID)
  s_cmp_eq_u32 s63, s98
  s_cbranch_scc1 L_w19
  buffer_store_dwordx4 v[140:143], v2, s[12:15], s74 offen sc1
  s_branch L_w19_x
L_w19:
  buffer_store_dwordx4 v[140:143], v2, s[12:15], s74 offen
L_w19_x:
  s_waitcnt vmcnt(1)
L_ra:
  v_readfirstlane_b32 s76, v40
  v_readfirstlane_b32 s77, v41
  s_nop 0
  s_cmp_eq_u32 s77, s46
  s_cbranch_scc1 L_ra_ok
  s_sub_u32 s78, s78, 1
  s_cbranch_scc1 L_ra_ok
  v_mov_b32 v40, 1
  v_mov_b32 v41, 0
  s_mov_b64 exec, 1
  buffer_atomic_add_x2 v[40:41], v2, s[12:15], s73 offen sc0
  s_mov_b64 exec, -1
  s_waitcnt vmcnt(0)
  s_branch L_ra
L_ra_ok:
  s_cmp_eq_u32 s76, 0
  s_cselect_b32 s49, s55, 255
  s_add_u32 s63, s49, 1
  v_mov_b32 v10, s63
  ds_write_b32 v147, v10 offset:72
  v_add_u32 v157, 6144, v157
  v_add_u32 v158, 6144, v158
  v_add_u32 v159, 6144, v159
  s_add_u32 s74, s74, 0x40000
  s_lshr_b32 s63, s47, 2
  s_cmp_lg_u32 s63, 1
  s_cbranch_scc1 L_c20
  s_and_b32 s73, s47, 3
  s_lshl_b32 s73, s73, 8
  s_lshl_b32 s66, s48, 15
  s_add_u32 s66, s66, s73
  s_add_u32 s66, s66, 1310720
  s_add_u32 s67, s66, 4096
  s_add_u32 s68, s66, 8192
  s_add_u32 s69, s66, 12288
  s_add_u32 s70, s66, 16384
  s_add_u32 s71, s66, 20480
  s_add_u32 s72, s66, 24576
  s_add_u32 s73, s66, 28672
  s_mov_b32 s78, 1000000
L_p21:
  buffer_load_dwordx4 v[112:115], v154, s[12:15], s66 offen sc1 nt
  buffer_load_dwordx4 v[116:119], v154, s[12:15], s67 offen sc1 nt
  buffer_load_dwordx4 v[120:123], v154, s[12:15], s68 offen sc1 nt
  buffer_load_dwordx4 v[124:127], v154, s[12:15], s69 offen sc1 nt
  buffer_load_dwordx4 v[128:131], v154, s[12:15], s70 offen sc1 nt
  buffer_load_dwordx4 v[132:135], v154, s[12:15], s71 offen sc1 nt
  buffer_load_dwordx4 v[136:139], v154, s[12:15], s72 offen sc1 nt
  buffer_load_dwordx4 v[140:143], v154, s[12:15], s73 offen sc1 nt
  s_sub_u32 s78, s78, 1
  s_cbranch_scc1 L_p21_x
  s_waitcnt vmcnt(0)
  v_min_u32 v10, v115, v143
  v_max_u32 v11, v115, v143
  v_min3_u32 v10, v10, v119, v123
  v_max3_u32 v11, v11, v119, v123
  v_min3_u32 v10, v10, v127, v131
  v_max3_u32 v11, v11, v127, v131
  v_min3_u32 v10, v10, v135, v139
  v_max3_u32 v11, v11, v135, v139
  v_cmp_ne_u32 vcc, s46, v10
  v_cmp_ne_u32 s[80:81], s46, v11
  s_nop 0
  s_or_b64 vcc, vcc, s[80:81]
  s_cbranch_vccz L_p21_x
  s_sleep 32
  s_branch L_p21
L_p21_x:
  s_waitcnt vmcnt(0)
  v_pk_add_f32 v[112:113], v[112:113], v[116:117]
  v_add_f32 v114, v114, v118
  v_pk_add_f32 v[120:121], v[120:121], v[124:125]
  v_add_f32 v122, v122, v126
  v_pk_add_f32 v[128:129], v[128:129], v[132:133]
  v_add_f32 v130, v130, v134
  v_pk_add_f32 v[136:137], v[136:137], v[140:141]
  v_add_f32 v138, v138, v142
  v_pk_add_f32 v[112:113], v[112:113], v[120:121]
  v_add_f32 v114, v114, v122
  v_pk_add_f32 v[128:129], v[128:129], v[136:137]
  v_add_f32 v130, v130, v138
  v_pk_add_f32 v[20:21], v[112:113], v[128:129]
  v_add_f32 v22, v114, v130
  v_mov_b32 v112, v20
  v_mov_b32 v113, v21
  v_mov_b32 v114, v22
  v_permlane16_swap_b32 v20, v112
  v_permlane16_swap_b32 v21, v113
  v_permlane16_swap_b32 v22, v114
  v_add_f32 v20, v20, v112
  v_add_f32 v21, v21, v113
  v_add_f32 v22, v22, v114
  v_mov_b32 v112, v20
  v_mov_b32 v113, v21
  v_mov_b32 v114, v22
  v_permlane32_swap_b32 v20, v112
  v_permlane32_swap_b32 v21, v113
  v_permlane32_swap_b32 v22, v114
  v_add_f32 v20, v20, v112
  v_add_f32 v21, v21, v113
  v_add_f32 v22, v22, v114
  v_cvt_pk_bf16_f32 v20, v20, v20
  v_cvt_pk_bf16_f32 v21, v21, v21
  v_cvt_pk_bf16_f32 v22, v22, v22
  s_and_b32 s73, s47, 3
  s_lshl_b32 s73, s73, 8
  s_lshl_b32 s63, s48, 10
  s_add_u32 s63, s63, s73
  s_add_u32 s63, s63, 40960
  v_mov_b32 v23, s46
  s_mov_b64 exec, 0xffff
  buffer_store_dwordx4 v[20:23], v2, s[12:15], s63 offen sc1
  s_mov_b64 exec, -1
  v_mov_b32 v143, s46
L_c20:
  s_mov_b32 s78, 1000000
L_f22:
  ds_read_b32 v9, v147 offset:44
  s_sub_u32 s78, s78, 1
  s_cbranch_scc1 L_f22_x
  s_waitcnt lgkmcnt(0)
  v_readfirstlane_b32 s63, v9
  s_nop 0
  s_cmp_ge_u32 s63, 4
  s_cbranch_scc1 L_f22_x
  s_sleep 8
  s_branch L_f22
L_f22_x:
  s_waitcnt lgkmcnt(0)
  s_lshr_b32 s63, s47, 2
  s_cmp_lg_u32 s63, 2
  s_cbranch_scc1 L_c23
  s_and_b32 s73, s47, 3
  s_lshl_b32 s73, s73, 8
  s_lshl_b32 s66, s48, 15
  s_add_u32 s66, s66, s73
  s_add_u32 s66, s66, 1572864
  s_add_u32 s67, s66, 4096
  s_add_u32 s68, s66, 8192
  s_add_u32 s69, s66, 12288
  s_add_u32 s70, s66, 16384
  s_add_u32 s71, s66, 20480
  s_add_u32 s72, s66, 24576
  s_add_u32 s73, s66, 28672
  s_mov_b32 s78, 1000000
L_p24:
  buffer_load_dwordx4 v[112:115], v154, s[12:15], s66 offen sc1 nt
  buffer_load_dwordx4 v[116:119], v154, s[12:15], s67 offen sc1 nt
  buffer_load_dwordx4 v[120:123], v154, s[12:15], s68 offen sc1 nt
  buffer_load_dwordx4 v[124:127], v154, s[12:15], s69 offen sc1 nt
  buffer_load_dwordx4 v[128:131], v154, s[12:15], s70 offen sc1 nt
  buffer_load_dwordx4 v[132:135], v154, s[12:15], s71 offen sc1 nt
  buffer_load_dwordx4 v[136:139], v154, s[12:15], s72 offen sc1 nt
  buffer_load_dwordx4 v[140:143], v154, s[12:15], s73 offen sc1 nt
  s_sub_u32 s78, s78, 1
  s_cbranch_scc1 L_p24_x
  s_waitcnt vmcnt(0)
  v_min_u32 v10, v115, v143
  v_max_u32 v11, v115, v143
  v_min3_u32 v10, v10, v119, v123
  v_max3_u32 v11, v11, v119, v123
  v_min3_u32 v10, v10, v127, v131
  v_max3_u32 v11, v11, v127, v131
  v_min3_u32 v10, v10, v135, v139
  v_max3_u32 v11, v11, v135, v139
  v_cmp_ne_u32 vcc, s46, v10
  v_cmp_ne_u32 s[80:81], s46, v11
  s_nop 0
  s_or_b64 vcc, vcc, s[80:81]
  s_cbranch_vccz L_p24_x
  s_sleep 32
  s_branch L_p24
L_p24_x:
  s_waitcnt vmcnt(0)
  v_pk_add_f32 v[112:113], v[112:113], v[116:117]
  v_add_f32 v114, v114, v118
  v_pk_add_f32 v[120:121], v[120:121], v[124:125]
  v_add_f32 v122, v122, v126
  v_pk_add_f32 v[128:129], v[128:129], v[132:133]
  v_add_f32 v130, v130, v134
  v_pk_add_f32 v[136:137], v[136:137], v[140:141]
  v_add_f32 v138, v138, v142
  v_pk_add_f32 v[112:113], v[112:113], v[120:121]
  v_add_f32 v114, v114, v122
  v_pk_add_f32 v[128:129], v[128:129], v[136:137]
  v_add_f32 v130, v130, v138
  v_pk_add_f32 v[20:21], v[112:113], v[128:129]
  v_add_f32 v22, v114, v130
  v_mov_b32 v112, v20
  v_mov_b32 v113, v21
  v_mov_b32 v114, v22
  v_permlane16_swap_b32 v20, v112
  v_permlane16_swap_b32 v21, v113
  v_permlane16_swap_b32 v22, v114
  v_add_f32 v20, v20, v112
  v_add_f32 v21, v21, v113
  v_add_f32 v22, v22, v114
  v_mov_b32 v112, v20
  v_mov_b32 v113, v21
  v_mov_b32 v114, v22
  v_permlane32_swap_b32 v20, v112
  v_permlane32_swap_b32 v21, v113
  v_permlane32_swap_b32 v22, v114
  v_add_f32 v20, v20, v112
  v_add_f32 v21, v21, v113
  v_add_f32 v22, v22, v114
  v_cvt_pk_bf16_f32 v20, v20, v20
  v_cvt_pk_bf16_f32 v21, v21, v21
  v_cvt_pk_bf16_f32 v22, v22, v22
  s_and_b32 s73, s47, 3
  s_lshl_b32 s73, s73, 8
  s_lshl_b32 s63, s48, 10
  s_add_u32 s63, s63, s73
  s_add_u32 s63, s63, 49152
  v_mov_b32 v23, s46
  s_mov_b64 exec, 0xffff
  buffer_store_dwordx4 v[20:23], v2, s[12:15], s63 offen sc1
  s_mov_b64 exec, -1
  v_mov_b32 v143, s46
L_c23:
  v_lshlrev_b32 v10, 21, v0
  s_mov_b64 exec, 15
  s_mov_b32 s16, s32
  s_and_b32 s17, s33, 0xffff
  s_mov_b32 s18, 7864320
  s_mov_b32 s19, 0x20000
  buffer_load_dword v11, v10, s[16:19], 0 offen
  s_mov_b64 exec, 1
  s_mov_b32 s16, s36
  s_and_b32 s17, s37, 0xffff
  s_mov_b32 s18, 1966080
  s_mov_b32 s19, 0x20000
  buffer_load_dword v11, v10, s[16:19], 0 offen
  s_mov_b32 s16, s38
  s_and_b32 s17, s39, 0xffff
  s_mov_b32 s18, 1966080
  s_mov_b32 s19, 0x20000
  buffer_load_dword v11, v10, s[16:19], 0 offen
  s_mov_b32 s16, s40
  s_and_b32 s17, s41, 0xffff
  s_mov_b32 s18, 1280
  s_mov_b32 s19, 0x20000
  buffer_load_dword v11, v10, s[16:19], 0 offen
  s_mov_b64 exec, -1
  s_lshl_b32 s74, s96, 5
  s_add_u32 s74, s74, s97
  s_lshl_b32 s74, s74, 10
  s_add_u32 s74, s74, 1835008
  s_mov_b32 s78, 1000000
L_f25:
  ds_read_b32 v9, v147 offset:48
  s_sub_u32 s78, s78, 1
  s_cbranch_scc1 L_f25_x
  s_waitcnt lgkmcnt(0)
  v_readfirstlane_b32 s63, v9
  s_nop 0
  s_cmp_ge_u32 s63, 3
  s_cbranch_scc1 L_f25_x
  s_sleep 1
  s_branch L_f25
L_f25_x:
  s_waitcnt lgkmcnt(0)
  s_cmp_lg_u32 s49, 255
  s_cbranch_scc1 L_noat
  v_mov_b32 v40, 1
  v_mov_b32 v41, 0
  s_mov_b64 exec, 1
  buffer_atomic_add_x2 v[40:41], v2, s[12:15], s99 offen sc0
  s_mov_b64 exec, -1
L_noat:
  s_barrier
  ds_read2st64_b32 v[112:113], v157 offset0:0 offset1:3
  ds_read2st64_b32 v[114:115], v157 offset0:6 offset1:9
  ds_read2st64_b32 v[116:117], v157 offset0:12 offset1:15
  ds_read2st64_b32 v[118:119], v157 offset0:18 offset1:21
  ds_read2st64_b32 v[120:121], v158 offset0:0 offset1:3
  ds_read2st64_b32 v[122:123], v158 offset0:6 offset1:9
  ds_read2st64_b32 v[124:125], v158 offset0:12 offset1:15
  ds_read2st64_b32 v[126:127], v158 offset0:18 offset1:21
  ds_read2st64_b32 v[128:129], v159 offset0:0 offset1:3
  ds_read2st64_b32 v[130:131], v159 offset0:6 offset1:9
  ds_read2st64_b32 v[132:133], v159 offset0:12 offset1:15
  ds_read2st64_b32 v[134:135], v159 offset0:18 offset1:21
  s_waitcnt lgkmcnt(8)
  v_add_f32 v112, v112, v113
  v_add_f32 v114, v114, v115
  v_add_f32 v116, v116, v117
  v_add_f32 v118, v118, v119
  v_add_f32 v112, v112, v114
  v_add_f32 v116, v116, v118
  v_add_f32 v140, v112, v116
  s_waitcnt lgkmcnt(4)
  v_add_f32 v120, v120, v121
  v_add_f32 v122, v122, v123
  v_add_f32 v124, v124, v125
  v_add_f32 v126, v126, v127
  v_add_f32 v120, v120, v122
  v_add_f32 v124, v124, v126
  v_add_f32 v141, v120, v124
  s_waitcnt lgkmcnt(0)
  v_add_f32 v128, v128, v129
  v_add_f32 v130, v130, v131
  v_add_f32 v132, v132, v133
  v_add_f32 v134, v134, v135
  v_add_f32 v128, v128, v130
  v_add_f32 v132, v132, v134
  v_add_f32 v142, v128, v132
  buffer_store_dwordx4 v[140:143], v2, s[12:15], s74 offen sc1
  s_cmp_lg_u32 s49, 255
  s_cbranch_scc1 L_role_set
  s_mov_b32 s78, 1000000
  s_waitcnt vmcnt(1)
L_role:
  v_readfirstlane_b32 s76, v40
  v_readfirstlane_b32 s77, v41
  s_nop 0
  s_cmp_eq_u32 s77, s46
  s_cbranch_scc1 L_role_ok
  s_sub_u32 s78, s78, 1
  s_cbranch_scc1 L_role_ok
  v_mov_b32 v40, 1
  v_mov_b32 v41, 0
  s_mov_b64 exec, 1
  buffer_atomic_add_x2 v[40:41], v2, s[12:15], s99 offen sc0
  s_mov_b64 exec, -1
  s_waitcnt vmcnt(0)
  s_branch L_role
L_role_ok:
  s_mul_i32 s64, s96, 10
  s_sub_u32 s63, s76, 11
  s_add_u32 s66, s63, s64
  s_add_u32 s66, s66, 0
  s_cmp_lt_u32 s63, 10
  s_cselect_b32 s49, s66, s49
  s_sub_u32 s63, s76, 1
  s_add_u32 s66, s63, s64
  s_add_u32 s66, s66, 128
  s_cmp_lt_u32 s63, 10
  s_cselect_b32 s49, s66, s49
L_role_set:
  v_mov_b32 v10, s49
  ds_write_b32 v147, v10 offset:52
  s_waitcnt lgkmcnt(0)
  s_barrier
  s_cmp_lt_u32 s49, 80
  s_cbranch_scc1 L_fin
  s_branch L_notW
L_stream:
  v_and_b32 v10, 15, v0
  v_lshrrev_b32 v11, 4, v0
  v_lshrrev_b32 v20, 1, v10
  v_mul_u32_u24 v20, 384, v20
  v_and_b32 v21, 1, v10
  v_lshl_add_u32 v20, v21, 6, v20
  v_lshl_add_u32 v1, v11, 4, v20
  v_mul_u32_u24 v11, 768, v11
  v_lshl_add_u32 v2, v10, 4, v11
  s_lshl_b32 s54, s47, 2
  s_add_u32 s54, s54, s3
  s_mul_i32 s50, s54, 3072
  s_mul_i32 s63, s48, 12582912
  s_add_u32 s50, s50, s63
  s_mov_b32 s75, s50
  s_waitcnt lgkmcnt(0)
  s_load_dword s46, s[44:45], 0
  s_mov_b32 s4, s26
  s_and_b32 s5, s27, 0xffff
  s_mov_b32 s6, 402653184
  s_mov_b32 s7, 0x20000
  buffer_load_dwordx4 v[48:51], v1, s[4:7], s50 offen offset:0 nt
  buffer_load_dwordx4 v[52:55], v1, s[4:7], s50 offen offset:128 nt
  buffer_load_dwordx4 v[56:59], v1, s[4:7], s50 offen offset:256 nt
  s_add_u32 s50, s50, 393216
  buffer_load_dwordx4 v[60:63], v1, s[4:7], s50 offen offset:0 nt
  buffer_load_dwordx4 v[64:67], v1, s[4:7], s50 offen offset:128 nt
  buffer_load_dwordx4 v[68:71], v1, s[4:7], s50 offen offset:256 nt
  s_add_u32 s50, s50, 393216
  s_barrier
  s_waitcnt vmcnt(5)
  buffer_load_dwordx4 v[72:75], v1, s[4:7], s50 offen offset:0 nt
  s_waitcnt vmcnt(5)
  buffer_load_dwordx4 v[76:79], v1, s[4:7], s50 offen offset:128 nt
  s_waitcnt vmcnt(5)
  buffer_load_dwordx4 v[80:83], v1, s[4:7], s50 offen offset:256 nt
  s_add_u32 s50, s50, 393216
  s_waitcnt vmcnt(5)
  buffer_load_dwordx4 v[84:87], v1, s[4:7], s50 offen offset:0 nt
  s_waitcnt vmcnt(5)
  buffer_load_dwordx4 v[88:91], v1, s[4:7], s50 offen offset:128 nt
  s_waitcnt vmcnt(5)
  buffer_load_dwordx4 v[92:95], v1, s[4:7], s50 offen offset:256 nt
  s_add_u32 s50, s50, 393216
  s_waitcnt vmcnt(5)
  buffer_load_dwordx4 v[96:99], v1, s[4:7], s50 offen offset:0 nt
  s_waitcnt vmcnt(5)
  buffer_load_dwordx4 v[100:103], v1, s[4:7], s50 offen offset:128 nt
  s_waitcnt vmcnt(5)
  buffer_load_dwordx4 v[104:107], v1, s[4:7], s50 offen offset:256 nt
  s_add_u32 s50, s50, 393216
  s_waitcnt vmcnt(5)
  buffer_load_dwordx4 v[108:111], v1, s[4:7], s50 offen offset:0 nt
  s_waitcnt vmcnt(5)
  buffer_load_dwordx4 v[112:115], v1, s[4:7], s50 offen offset:128 nt
  s_waitcnt vmcnt(5)
  buffer_load_dwordx4 v[116:119], v1, s[4:7], s50 offen offset:256 nt
  s_add_u32 s50, s50, 393216
  s_waitcnt vmcnt(5)
  buffer_load_dwordx4 v[120:123], v1, s[4:7], s50 offen offset:0 nt
  s_waitcnt vmcnt(5)
  buffer_load_dwordx4 v[124:127], v1, s[4:7], s50 offen offset:128 nt
  s_waitcnt vmcnt(5)
  buffer_load_dwordx4 v[128:131], v1, s[4:7], s50 offen offset:256 nt
  s_add_u32 s50, s50, 393216
  s_waitcnt vmcnt(5)
  buffer_load_dwordx4 v[132:135], v1, s[4:7], s50 offen offset:0 nt
  s_waitcnt vmcnt(5)
  buffer_load_dwordx4 v[136:139], v1, s[4:7], s50 offen offset:128 nt
  s_waitcnt vmcnt(5)
  buffer_load_dwordx4 v[140:143], v1, s[4:7], s50 offen offset:256 nt
  s_add_u32 s50, s50, 393216
  s_mov_b32 s8, s28
  s_and_b32 s9, s29, 0xffff
  s_mov_b32 s10, 402653184
  s_mov_b32 s11, 0x20000
  s_mov_b32 s12, s44
  s_and_b32 s13, s45, 0xffff
  s_mov_b32 s14, 3145728
  s_mov_b32 s15, 0x20000
  s_waitcnt vmcnt(5)
  buffer_load_dwordx4 a[0:3], v1, s[4:7], s50 offen offset:0 nt
  s_waitcnt vmcnt(5)
  buffer_load_dwordx4 a[4:7], v1, s[4:7], s50 offen offset:128 nt
  s_waitcnt vmcnt(5)
  buffer_load_dwordx4 a[8:11], v1, s[4:7], s50 offen offset:256 nt
  s_add_u32 s50, s50, 393216
  s_waitcnt vmcnt(5)
  buffer_load_dwordx4 a[12:15], v1, s[4:7], s50 offen offset:0 nt
  s_waitcnt vmcnt(5)
  buffer_load_dwordx4 a[16:19], v1, s[4:7], s50 offen offset:128 nt
  s_waitcnt vmcnt(5)
  buffer_load_dwordx4 a[20:23], v1, s[4:7], s50 offen offset:256 nt
  s_add_u32 s50, s50, 393216
  s_waitcnt vmcnt(5)
  buffer_load_dwordx4 a[24:27], v1, s[4:7], s50 offen offset:0 nt
  s_waitcnt vmcnt(5)
  buffer_load_dwordx4 a[28:31], v1, s[4:7], s50 offen offset:128 nt
  s_waitcnt vmcnt(5)
  buffer_load_dwordx4 a[32:35], v1, s[4:7], s50 offen offset:256 nt
  s_add_u32 s50, s50, 393216
  s_waitcnt vmcnt(5)
  buffer_load_dwordx4 a[36:39], v1, s[4:7], s50 offen offset:0 nt
  s_waitcnt vmcnt(5)
  buffer_load_dwordx4 a[40:43], v1, s[4:7], s50 offen offset:128 nt
  s_waitcnt vmcnt(5)
  buffer_load_dwordx4 a[44:47], v1, s[4:7], s50 offen offset:256 nt
  s_add_u32 s50, s50, 393216
  v_mov_b32 v147, 1536
  v_mov_b32 v148, 1
  s_mov_b64 exec, 1
  ds_add_u32 v147, v148 offset:76
  s_mov_b64 exec, -1
  s_waitcnt vmcnt(5)
  buffer_load_dwordx4 a[48:51], v1, s[4:7], s50 offen offset:0 nt
  s_waitcnt vmcnt(5)
  buffer_load_dwordx4 a[52:55], v1, s[4:7], s50 offen offset:128 nt
  s_waitcnt vmcnt(5)
  buffer_load_dwordx4 a[56:59], v1, s[4:7], s50 offen offset:256 nt
  s_add_u32 s50, s50, 393216
  s_waitcnt vmcnt(5)
  buffer_load_dwordx4 a[60:63], v1, s[4:7], s50 offen offset:0 nt
  s_waitcnt vmcnt(5)
  buffer_load_dwordx4 a[64:67], v1, s[4:7], s50 offen offset:128 nt
  s_waitcnt vmcnt(5)
  buffer_load_dwordx4 a[68:71], v1, s[4:7], s50 offen offset:256 nt
  s_add_u32 s50, s50, 393216
  s_waitcnt vmcnt(5)
  buffer_load_dwordx4 a[72:75], v1, s[4:7], s50 offen offset:0 nt
  s_waitcnt vmcnt(5)
  buffer_load_dwordx4 a[76:79], v1, s[4:7], s50 offen offset:128 nt
  s_waitcnt vmcnt(5)
  buffer_load_dwordx4 a[80:83], v1, s[4:7], s50 offen offset:256 nt
  s_add_u32 s50, s50, 393216
  s_waitcnt vmcnt(5)
  buffer_load_dwordx4 a[84:87], v1, s[4:7], s50 offen offset:0 nt
  s_waitcnt vmcnt(5)
  buffer_load_dwordx4 a[88:91], v1, s[4:7], s50 offen offset:128 nt
  s_waitcnt vmcnt(5)
  buffer_load_dwordx4 a[92:95], v1, s[4:7], s50 offen offset:256 nt
  s_add_u32 s50, s50, 393216
  s_mov_b32 s56, 0xaaaaaaaa
  s_mov_b32 s57, 0xaaaaaaaa
  s_mov_b32 s58, 0xff00ff00
  s_mov_b32 s59, 0xff00ff00
  s_mov_b32 s60, 0x3fb8aa3b
  s_mov_b32 s61, 0x3d93cd3a
  s_mov_b32 s62, 0xffff0000
  v_and_b32 v10, 1, v0
  v_mov_b32 v11, 0xffff
  v_lshlrev_b32 v10, 4, v10
  v_lshlrev_b32 v11, v10, v11
  v_bfe_u32 v10, v0, 1, 2
  v_cmp_eq_u32 vcc, 0, v10
  s_nop 1
  v_cndmask_b32 v3, 0, v11, vcc
  v_cmp_eq_u32 vcc, 1, v10
  s_nop 1
  v_cndmask_b32 v4, 0, v11, vcc
  v_cmp_eq_u32 vcc, 2, v10
  s_nop 1
  v_cndmask_b32 v5, 0, v11, vcc
  v_cmp_eq_u32 vcc, 3, v10
  s_nop 1
  v_cndmask_b32 v6, 0, v11, vcc
  s_mul_i32 s63, s3, 1536
  s_add_u32 s63, s63, 24576
  v_and_b32 v10, 15, v0
  v_lshrrev_b32 v11, 4, v0
  v_and_b32 v20, 1, v11
  v_lshlrev_b32 v20, 4, v20
  v_lshl_add_u32 v20, v10, 5, v20
  v_add_u32 v20, s63, v20
  v_lshlrev_b32 v21, 4, v0
  v_add_u32 v21, 3328, v21
  v_cmp_gt_u32 vcc, 32, v0
  s_nop 1
  v_cndmask_b32 v144, v21, v20, vcc
  v_add_u32 v22, 1024, v20
  v_cndmask_b32 v146, v22, v21, vcc
  v_add_u32 v22, 512, v20
  v_lshrrev_b32 v10, 3, v10
  v_lshrrev_b32 v11, 1, v11
  v_cmp_eq_u32 vcc, v10, v11
  s_nop 1
  v_cndmask_b32 v145, v21, v22, vcc
  v_lshrrev_b32 v8, 3, v0
  v_lshlrev_b32 v8, 4, v8
  s_lshl_b32 s63, s3, 2
  s_add_u32 s63, s63, 8192
  v_add_u32 v7, s63, v8
  v_mov_b32 v147, 1536
  v_mov_b32 v148, 1
  v_mov_b32 v150, v147
  v_mov_b32 v36, 0
  v_mov_b32 v37, 0
  v_mov_b32 v38, 0
  v_mov_b32 v39, 0
  v_mov_b32 v40, 0
  v_mov_b32 v41, 0
  v_mov_b32 v42, 0
  v_mov_b32 v43, 0
  v_mov_b32 v44, 0
  v_mov_b32 v45, 0
  v_mov_b32 v46, 0
  v_mov_b32 v47, 0
  v_and_b32 v149, 1, v0
  v_lshlrev_b32 v149, 6, v149
  v_lshrrev_b32 v11, 4, v0
  v_lshl_add_u32 v149, v11, 4, v149
  s_sub_u32 s63, s96, s48
  s_add_u32 s63, s63, 7
  s_mul_i32 s63, s63, 12582912
  s_sub_u32 s64, s97, s47
  s_mul_i32 s64, s64, 12288
  s_add_u32 s98, s63, s64
  s_lshl_b32 s55, s96, 16
  s_add_u32 s55, s55, 2098176
  s_add_u32 s63, s96, 24
  s_mul_i32 s53, s63, 12582912
  s_add_u32 s53, s53, 6291456
  s_and_b32 s74, s54, 15
  s_and_b32 s54, s54, 127
  s_lshl_b32 s54, s54, 8
  s_add_u32 s54, s54, 655360
  s_waitcnt lgkmcnt(0)
  s_mul_i32 s46, s46, 1664525
  s_add_u32 s46, s46, 1013904223
  s_barrier
  ds_read_b128 v[24:27], v149 offset:0
  ds_read_b128 v[28:31], v149 offset:128
  ds_read_b128 v[32:35], v149 offset:256
  v_add_u32 v149, 384, v149
  s_waitcnt lgkmcnt(0)
  s_waitcnt vmcnt(45)
  v_mfma_f32_16x16x32_bf16 v[12:15], v[48:51], v[24:27], 0
  v_mfma_f32_16x16x32_bf16 v[12:15], v[52:55], v[28:31], v[12:15]
  v_mfma_f32_16x16x32_bf16 v[12:15], v[56:59], v[32:35], v[12:15]
  s_waitcnt vmcnt(5)
  buffer_load_dwordx4 v[48:51], v1, s[4:7], s50 offen offset:0 nt
  s_waitcnt vmcnt(5)
  buffer_load_dwordx4 v[52:55], v1, s[4:7], s50 offen offset:128 nt
  s_waitcnt vmcnt(4)
  buffer_load_dwordx4 v[56:59], v1, s[4:7], s50 offen offset:256 nt
  s_add_u32 s50, s50, 393216
  s_nop 0
  v_cndmask_b32 v10, v12, v13, s[56:57]
  v_cndmask_b32 v11, v14, v15, s[56:57]
  v_cndmask_b32 v10, v10, v11, s[58:59]
  s_nop 1
  v_add_f32_dpp v10, v10, v10 quad_perm:[1,0,3,2] row_mask:0xf bank_mask:0xf
  v_cvt_pk_bf16_f32 v10, v10, v10
  v_and_b32 v10, s62, v10
  v_mul_f32 v10, s61, v10
  v_cvt_pk_bf16_f32 v10, v10, v10
  v_and_b32 v10, s62, v10
  ds_write_b32 v7, v10 offset:0
  v_mfma_f32_16x16x32_bf16 v[12:15], a[0:3], v[24:27], 0
  v_mfma_f32_16x16x32_bf16 v[12:15], a[4:7], v[28:31], v[12:15]
  v_mfma_f32_16x16x32_bf16 v[12:15], a[8:11], v[32:35], v[12:15]
  s_nop 7
  v_cndmask_b32 v10, v12, v13, s[56:57]
  v_cndmask_b32 v11, v14, v15, s[56:57]
  v_cndmask_b32 v10, v10, v11, s[58:59]
  s_nop 1
  v_add_f32_dpp v10, v10, v10 quad_perm:[1,0,3,2] row_mask:0xf bank_mask:0xf
  v_cvt_pk_bf16_f32 v10, v10, v10
  v_and_b32 v10, s62, v10
  v_mul_f32 v10, s61, v10
  v_cvt_pk_bf16_f32 v10, v10, v10
  v_and_b32 v10, s62, v10
  ds_write_b32 v7, v10 offset:1024
  v_mfma_f32_16x16x32_bf16 v[12:15], v[60:63], v[24:27], 0
  v_mfma_f32_16x16x32_bf16 v[12:15], v[64:67], v[28:31], v[12:15]
  v_mfma_f32_16x16x32_bf16 v[12:15], v[68:71], v[32:35], v[12:15]
  s_waitcnt vmcnt(5)
  buffer_load_dwordx4 v[60:63], v1, s[4:7], s50 offen offset:0 nt
  s_waitcnt vmcnt(5)
  buffer_load_dwordx4 v[64:67], v1, s[4:7], s50 offen offset:128 nt
  s_waitcnt vmcnt(4)
  buffer_load_dwordx4 v[68:71], v1, s[4:7], s50 offen offset:256 nt
  s_add_u32 s50, s50, 393216
  s_nop 0
  v_cndmask_b32 v10, v12, v13, s[56:57]
  v_cndmask_b32 v11, v14, v15, s[56:57]
  v_cndmask_b32 v10, v10, v11, s[58:59]
  s_nop 1
  v_add_f32_dpp v10, v10, v10 quad_perm:[1,0,3,2] row_mask:0xf bank_mask:0xf
  v_cvt_pk_bf16_f32 v10, v10, v10
  v_and_b32 v10, s62, v10
  v_mul_f32 v10, s61, v10
  v_cvt_pk_bf16_f32 v10, v10, v10
  v_and_b32 v10, s62, v10
  ds_write_b32 v7, v10 offset:128
  v_mfma_f32_16x16x32_bf16 v[12:15], a[12:15], v[24:27], 0
  v_mfma_f32_16x16x32_bf16 v[12:15], a[16:19], v[28:31], v[12:15]
  v_mfma_f32_16x16x32_bf16 v[12:15], a[20:23], v[32:35], v[12:15]
  s_nop 7
  v_cndmask_b32 v10, v12, v13, s[56:57]
  v_cndmask_b32 v11, v14, v15, s[56:57]
  v_cndmask_b32 v10, v10, v11, s[58:59]
  s_nop 1
  v_add_f32_dpp v10, v10, v10 quad_perm:[1,0,3,2] row_mask:0xf bank_mask:0xf
  v_cvt_pk_bf16_f32 v10, v10, v10
  v_and_b32 v10, s62, v10
  v_mul_f32 v10, s61, v10
  v_cvt_pk_bf16_f32 v10, v10, v10
  v_and_b32 v10, s62, v10
  ds_write_b32 v7, v10 offset:1152
  v_mfma_f32_16x16x32_bf16 v[12:15], v[72:75], v[24:27], 0
  v_mfma_f32_16x16x32_bf16 v[12:15], v[76:79], v[28:31], v[12:15]
  v_mfma_f32_16x16x32_bf16 v[12:15], v[80:83], v[32:35], v[12:15]
  s_waitcnt vmcnt(5)
  buffer_load_dwordx4 v[72:75], v1, s[4:7], s50 offen offset:0 nt
  s_waitcnt vmcnt(5)
  buffer_load_dwordx4 v[76:79], v1, s[4:7], s50 offen offset:128 nt
  s_waitcnt vmcnt(4)
  buffer_load_dwordx4 v[80:83], v1, s[4:7], s50 offen offset:256 nt
  s_add_u32 s50, s50, 393216
  s_nop 0
  v_cndmask_b32 v10, v12, v13, s[56:57]
  v_cndmask_b32 v11, v14, v15, s[56:57]
  v_cndmask_b32 v10, v10, v11, s[58:59]
  s_nop 1
  v_add_f32_dpp v10, v10, v10 quad_perm:[1,0,3,2] row_mask:0xf bank_mask:0xf
  v_cvt_pk_bf16_f32 v10, v10, v10
  v_and_b32 v10, s62, v10
  v_mul_f32 v10, s61, v10
  v_cvt_pk_bf16_f32 v10, v10, v10
  v_and_b32 v10, s62, v10
  ds_write_b32 v7, v10 offset:256
  v_mfma_f32_16x16x32_bf16 v[12:15], a[24:27], v[24:27], 0
  v_mfma_f32_16x16x32_bf16 v[12:15], a[28:31], v[28:31], v[12:15]
  v_mfma_f32_16x16x32_bf16 v[12:15], a[32:35], v[32:35], v[12:15]
  s_nop 7
  v_cndmask_b32 v10, v12, v13, s[56:57]
  v_cndmask_b32 v11, v14, v15, s[56:57]
  v_cndmask_b32 v10, v10, v11, s[58:59]
  s_nop 1
  v_add_f32_dpp v10, v10, v10 quad_perm:[1,0,3,2] row_mask:0xf bank_mask:0xf
  v_cvt_pk_bf16_f32 v10, v10, v10
  v_and_b32 v10, s62, v10
  v_mul_f32 v10, s61, v10
  v_cvt_pk_bf16_f32 v10, v10, v10
  v_and_b32 v10, s62, v10
  ds_write_b32 v7, v10 offset:1280
  v_mfma_f32_16x16x32_bf16 v[12:15], v[84:87], v[24:27], 0
  v_mfma_f32_16x16x32_bf16 v[12:15], v[88:91], v[28:31], v[12:15]
  v_mfma_f32_16x16x32_bf16 v[12:15], v[92:95], v[32:35], v[12:15]
  s_waitcnt vmcnt(5)
  buffer_load_dwordx4 v[84:87], v1, s[4:7], s50 offen offset:0 nt
  s_waitcnt vmcnt(5)
  buffer_load_dwordx4 v[88:91], v1, s[4:7], s50 offen offset:128 nt
  s_waitcnt vmcnt(4)
  buffer_load_dwordx4 v[92:95], v1, s[4:7], s50 offen offset:256 nt
  s_add_u32 s50, s50, 393216
  s_nop 0
  v_cndmask_b32 v10, v12, v13, s[56:57]
  v_cndmask_b32 v11, v14, v15, s[56:57]
  v_cndmask_b32 v10, v10, v11, s[58:59]
  s_nop 1
  v_add_f32_dpp v10, v10, v10 quad_perm:[1,0,3,2] row_mask:0xf bank_mask:0xf
  v_cvt_pk_bf16_f32 v10, v10, v10
  v_and_b32 v10, s62, v10
  v_mul_f32 v10, s61, v10
  v_cvt_pk_bf16_f32 v10, v10, v10
  v_and_b32 v10, s62, v10
  ds_write_b32 v7, v10 offset:384
  v_mfma_f32_16x16x32_bf16 v[12:15], a[36:39], v[24:27], 0
  v_mfma_f32_16x16x32_bf16 v[12:15], a[40:43], v[28:31], v[12:15]
  v_mfma_f32_16x16x32_bf16 v[12:15], a[44:47], v[32:35], v[12:15]
  s_nop 7
  v_cndmask_b32 v10, v12, v13, s[56:57]
  v_cndmask_b32 v11, v14, v15, s[56:57]
  v_cndmask_b32 v10, v10, v11, s[58:59]
  s_nop 1
  v_add_f32_dpp v10, v10, v10 quad_perm:[1,0,3,2] row_mask:0xf bank_mask:0xf
  v_cvt_pk_bf16_f32 v10, v10, v10
  v_and_b32 v10, s62, v10
  v_mul_f32 v10, s61, v10
  v_cvt_pk_bf16_f32 v10, v10, v10
  v_and_b32 v10, s62, v10
  ds_write_b32 v7, v10 offset:1408
  v_mfma_f32_16x16x32_bf16 v[12:15], v[96:99], v[24:27], 0
  v_mfma_f32_16x16x32_bf16 v[12:15], v[100:103], v[28:31], v[12:15]
  v_mfma_f32_16x16x32_bf16 v[12:15], v[104:107], v[32:35], v[12:15]
  s_waitcnt vmcnt(5)
  buffer_load_dwordx4 v[96:99], v1, s[4:7], s50 offen offset:0 nt
  s_waitcnt vmcnt(5)
  buffer_load_dwordx4 v[100:103], v1, s[4:7], s50 offen offset:128 nt
  s_waitcnt vmcnt(4)
  buffer_load_dwordx4 v[104:107], v1, s[4:7], s50 offen offset:256 nt
  s_add_u32 s50, s50, 393216
  s_nop 0
  v_cndmask_b32 v10, v12, v13, s[56:57]
  v_cndmask_b32 v11, v14, v15, s[56:57]
  v_cndmask_b32 v10, v10, v11, s[58:59]
  s_nop 1
  v_add_f32_dpp v10, v10, v10 quad_perm:[1,0,3,2] row_mask:0xf bank_mask:0xf
  v_cvt_pk_bf16_f32 v10, v10, v10
  v_and_b32 v10, s62, v10
  v_mul_f32 v10, s61, v10
  v_cvt_pk_bf16_f32 v10, v10, v10
  v_and_b32 v10, s62, v10
  ds_write_b32 v7, v10 offset:512
  v_mfma_f32_16x16x32_bf16 v[12:15], a[48:51], v[24:27], 0
  v_mfma_f32_16x16x32_bf16 v[12:15], a[52:55], v[28:31], v[12:15]
  v_mfma_f32_16x16x32_bf16 v[12:15], a[56:59], v[32:35], v[12:15]
  s_nop 7
  v_cndmask_b32 v10, v12, v13, s[56:57]
  v_cndmask_b32 v11, v14, v15, s[56:57]
  v_cndmask_b32 v10, v10, v11, s[58:59]
  s_nop 1
  v_add_f32_dpp v10, v10, v10 quad_perm:[1,0,3,2] row_mask:0xf bank_mask:0xf
  v_cvt_pk_bf16_f32 v10, v10, v10
  v_and_b32 v10, s62, v10
  v_mul_f32 v10, s61, v10
  v_cvt_pk_bf16_f32 v10, v10, v10
  v_and_b32 v10, s62, v10
  ds_write_b32 v7, v10 offset:1536
  v_mfma_f32_16x16x32_bf16 v[12:15], v[108:111], v[24:27], 0
  v_mfma_f32_16x16x32_bf16 v[12:15], v[112:115], v[28:31], v[12:15]
  v_mfma_f32_16x16x32_bf16 v[12:15], v[116:119], v[32:35], v[12:15]
  s_waitcnt vmcnt(5)
  buffer_load_dwordx4 v[108:111], v1, s[4:7], s50 offen offset:0 nt
  s_waitcnt vmcnt(5)
  buffer_load_dwordx4 v[112:115], v1, s[4:7], s50 offen offset:128 nt
  s_waitcnt vmcnt(4)
  buffer_load_dwordx4 v[116:119], v1, s[4:7], s50 offen offset:256 nt
  s_add_u32 s50, s50, 393216
  s_nop 0
  v_cndmask_b32 v10, v12, v13, s[56:57]
  v_cndmask_b32 v11, v14, v15, s[56:57]
  v_cndmask_b32 v10, v10, v11, s[58:59]
  s_nop 1
  v_add_f32_dpp v10, v10, v10 quad_perm:[1,0,3,2] row_mask:0xf bank_mask:0xf
  v_cvt_pk_bf16_f32 v10, v10, v10
  v_and_b32 v10, s62, v10
  v_mul_f32 v10, s61, v10
  v_cvt_pk_bf16_f32 v10, v10, v10
  v_and_b32 v10, s62, v10
  ds_write_b32 v7, v10 offset:640
  v_mfma_f32_16x16x32_bf16 v[12:15], a[60:63], v[24:27], 0
  v_mfma_f32_16x16x32_bf16 v[12:15], a[64:67], v[28:31], v[12:15]
  v_mfma_f32_16x16x32_bf16 v[12:15], a[68:71], v[32:35], v[12:15]
  s_nop 7
  v_cndmask_b32 v10, v12, v13, s[56:57]
  v_cndmask_b32 v11, v14, v15, s[56:57]
  v_cndmask_b32 v10, v10, v11, s[58:59]
  s_nop 1
  v_add_f32_dpp v10, v10, v10 quad_perm:[1,0,3,2] row_mask:0xf bank_mask:0xf
  v_cvt_pk_bf16_f32 v10, v10, v10
  v_and_b32 v10, s62, v10
  v_mul_f32 v10, s61, v10
  v_cvt_pk_bf16_f32 v10, v10, v10
  v_and_b32 v10, s62, v10
  ds_write_b32 v7, v10 offset:1664
  v_mfma_f32_16x16x32_bf16 v[12:15], v[120:123], v[24:27], 0
  v_mfma_f32_16x16x32_bf16 v[12:15], v[124:127], v[28:31], v[12:15]
  v_mfma_f32_16x16x32_bf16 v[12:15], v[128:131], v[32:35], v[12:15]
  s_waitcnt vmcnt(5)
  buffer_load_dwordx4 v[120:123], v1, s[4:7], s50 offen offset:0 nt
  s_waitcnt vmcnt(5)
  buffer_load_dwordx4 v[124:127], v1, s[4:7], s50 offen offset:128 nt
  s_waitcnt vmcnt(4)
  buffer_load_dwordx4 v[128:131], v1, s[4:7], s50 offen offset:256 nt
  s_add_u32 s50, s50, 393216
  s_nop 0
  v_cndmask_b32 v10, v12, v13, s[56:57]
  v_cndmask_b32 v11, v14, v15, s[56:57]
  v_cndmask_b32 v10, v10, v11, s[58:59]
  s_nop 1
  v_add_f32_dpp v10, v10, v10 quad_perm:[1,0,3,2] row_mask:0xf bank_mask:0xf
  v_cvt_pk_bf16_f32 v10, v10, v10
  v_and_b32 v10, s62, v10
  v_mul_f32 v10, s61, v10
  v_cvt_pk_bf16_f32 v10, v10, v10
  v_and_b32 v10, s62, v10
  ds_write_b32 v7, v10 offset:768
  v_mfma_f32_16x16x32_bf16 v[12:15], a[72:75], v[24:27], 0
  v_mfma_f32_16x16x32_bf16 v[12:15], a[76:79], v[28:31], v[12:15]
  v_mfma_f32_16x16x32_bf16 v[12:15], a[80:83], v[32:35], v[12:15]
  s_nop 7
  v_cndmask_b32 v10, v12, v13, s[56:57]
  v_cndmask_b32 v11, v14, v15, s[56:57]
  v_cndmask_b32 v10, v10, v11, s[58:59]
  s_nop 1
  v_add_f32_dpp v10, v10, v10 quad_perm:[1,0,3,2] row_mask:0xf bank_mask:0xf
  v_cvt_pk_bf16_f32 v10, v10, v10
  v_and_b32 v10, s62, v10
  v_mul_f32 v10, s61, v10
  v_cvt_pk_bf16_f32 v10, v10, v10
  v_and_b32 v10, s62, v10
  ds_write_b32 v7, v10 offset:1792
  v_mfma_f32_16x16x32_bf16 v[12:15], v[132:135], v[24:27], 0
  v_mfma_f32_16x16x32_bf16 v[12:15], v[136:139], v[28:31], v[12:15]
  v_mfma_f32_16x16x32_bf16 v[12:15], v[140:143], v[32:35], v[12:15]
  s_waitcnt vmcnt(5)
  buffer_load_dwordx4 v[132:135], v1, s[4:7], s50 offen offset:0 nt
  s_waitcnt vmcnt(5)
  buffer_load_dwordx4 v[136:139], v1, s[4:7], s50 offen offset:128 nt
  s_waitcnt vmcnt(4)
  buffer_load_dwordx4 v[140:143], v1, s[4:7], s50 offen offset:256 nt
  s_add_u32 s50, s50, 393216
  s_nop 0
  v_cndmask_b32 v10, v12, v13, s[56:57]
  v_cndmask_b32 v11, v14, v15, s[56:57]
  v_cndmask_b32 v10, v10, v11, s[58:59]
  s_nop 1
  v_add_f32_dpp v10, v10, v10 quad_perm:[1,0,3,2] row_mask:0xf bank_mask:0xf
  v_cvt_pk_bf16_f32 v10, v10, v10
  v_and_b32 v10, s62, v10
  v_mul_f32 v10, s61, v10
  v_cvt_pk_bf16_f32 v10, v10, v10
  v_and_b32 v10, s62, v10
  ds_write_b32 v7, v10 offset:896
  v_mfma_f32_16x16x32_bf16 v[12:15], a[84:87], v[24:27], 0
  v_mfma_f32_16x16x32_bf16 v[12:15], a[88:91], v[28:31], v[12:15]
  v_mfma_f32_16x16x32_bf16 v[12:15], a[92:95], v[32:35], v[12:15]
  s_nop 7
  v_cndmask_b32 v10, v12, v13, s[56:57]
  v_cndmask_b32 v11, v14, v15, s[56:57]
  v_cndmask_b32 v10, v10, v11, s[58:59]
  s_nop 1
  v_add_f32_dpp v10, v10, v10 quad_perm:[1,0,3,2] row_mask:0xf bank_mask:0xf
  v_cvt_pk_bf16_f32 v10, v10, v10
  v_and_b32 v10, s62, v10
  v_mul_f32 v10, s61, v10
  v_cvt_pk_bf16_f32 v10, v10, v10
  v_and_b32 v10, s62, v10
  ds_write_b32 v7, v10 offset:1920
  v_add_u32 v7, 2048, v7
  s_mov_b32 s78, 1000000
L_f26:
  ds_read_b32 v9, v147 offset:60
  s_sub_u32 s78, s78, 1
  s_cbranch_scc1 L_f26_x
  s_waitcnt lgkmcnt(0)
  v_readfirstlane_b32 s63, v9
  s_nop 0
  s_cmp_ge_u32 s63, 1
  s_cbranch_scc1 L_f26_x
  s_sleep 1
  s_branch L_f26
L_f26_x:
  s_waitcnt lgkmcnt(0)
  s_waitcnt vmcnt(21)
  v_mfma_f32_16x16x32_bf16 v[12:15], v[48:51], v[24:27], 0
  v_mfma_f32_16x16x32_bf16 v[12:15], v[52:55], v[28:31], v[12:15]
  v_mfma_f32_16x16x32_bf16 v[12:15], v[56:59], v[32:35], v[12:15]
  s_nop 7
  v_cndmask_b32 v10, v12, v13, s[56:57]
  v_cndmask_b32 v11, v14, v15, s[56:57]
  v_cndmask_b32 v10, v10, v11, s[58:59]
  s_nop 1
  v_add_f32_dpp v10, v10, v10 quad_perm:[1,0,3,2] row_mask:0xf bank_mask:0xf
  v_cvt_pk_bf16_f32 v10, v10, v10
  v_and_b32 v10, s62, v10
  v_mul_f32 v10, s61, v10
  v_cvt_pk_bf16_f32 v10, v10, v10
  v_and_b32 v10, s62, v10
  ds_write_b32 v7, v10 offset:0
  s_waitcnt vmcnt(5)
  buffer_load_dwordx4 v[48:51], v1, s[4:7], s50 offen offset:0 nt
  s_waitcnt vmcnt(5)
  buffer_load_dwordx4 v[52:55], v1, s[4:7], s50 offen offset:128 nt
  s_waitcnt vmcnt(4)
  buffer_load_dwordx4 v[56:59], v1, s[4:7], s50 offen offset:256 nt
  s_add_u32 s50, s50, 393216
  v_mfma_f32_16x16x32_bf16 v[12:15], v[60:63], v[24:27], 0
  v_mfma_f32_16x16x32_bf16 v[12:15], v[64:67], v[28:31], v[12:15]
  v_mfma_f32_16x16x32_bf16 v[12:15], v[68:71], v[32:35], v[12:15]
  s_nop 7
  v_cndmask_b32 v10, v12, v13, s[56:57]
  v_cndmask_b32 v11, v14, v15, s[56:57]
  v_cndmask_b32 v10, v10, v11, s[58:59]
  s_nop 1
  v_add_f32_dpp v10, v10, v10 quad_perm:[1,0,3,2] row_mask:0xf bank_mask:0xf
  v_cvt_pk_bf16_f32 v10, v10, v10
  v_and_b32 v10, s62, v10
  v_mul_f32 v10, s61, v10
  v_cvt_pk_bf16_f32 v10, v10, v10
  v_and_b32 v10, s62, v10
  ds_write_b32 v7, v10 offset:128
  s_waitcnt vmcnt(5)
  buffer_load_dwordx4 v[60:63], v1, s[4:7], s50 offen offset:0 nt
  s_waitcnt vmcnt(5)
  buffer_load_dwordx4 v[64:67], v1, s[4:7], s50 offen offset:128 nt
  s_waitcnt vmcnt(4)
  buffer_load_dwordx4 v[68:71], v1, s[4:7], s50 offen offset:256 nt
  s_add_u32 s50, s50, 393216
  v_mfma_f32_16x16x32_bf16 v[12:15], v[72:75], v[24:27], 0
  v_mfma_f32_16x16x32_bf16 v[12:15], v[76:79], v[28:31], v[12:15]
  v_mfma_f32_16x16x32_bf16 v[12:15], v[80:83], v[32:35], v[12:15]
  s_nop 7
  v_cndmask_b32 v10, v12, v13, s[56:57]
  v_cndmask_b32 v11, v14, v15, s[56:57]
  v_cndmask_b32 v10, v10, v11, s[58:59]
  s_nop 1
  v_add_f32_dpp v10, v10, v10 quad_perm:[1,0,3,2] row_mask:0xf bank_mask:0xf
  v_cvt_pk_bf16_f32 v10, v10, v10
  v_and_b32 v10, s62, v10
  v_mul_f32 v10, s61, v10
  v_cvt_pk_bf16_f32 v10, v10, v10
  v_and_b32 v10, s62, v10
  ds_write_b32 v7, v10 offset:256
  s_waitcnt vmcnt(5)
  buffer_load_dwordx4 v[72:75], v1, s[4:7], s50 offen offset:0 nt
  s_waitcnt vmcnt(5)
  buffer_load_dwordx4 v[76:79], v1, s[4:7], s50 offen offset:128 nt
  s_waitcnt vmcnt(4)
  buffer_load_dwordx4 v[80:83], v1, s[4:7], s50 offen offset:256 nt
  s_add_u32 s50, s50, 393216
  v_mfma_f32_16x16x32_bf16 v[12:15], v[84:87], v[24:27], 0
  v_mfma_f32_16x16x32_bf16 v[12:15], v[88:91], v[28:31], v[12:15]
  v_mfma_f32_16x16x32_bf16 v[12:15], v[92:95], v[32:35], v[12:15]
  s_nop 7
  v_cndmask_b32 v10, v12, v13, s[56:57]
  v_cndmask_b32 v11, v14, v15, s[56:57]
  v_cndmask_b32 v10, v10, v11, s[58:59]
  s_nop 1
  v_add_f32_dpp v10, v10, v10 quad_perm:[1,0,3,2] row_mask:0xf bank_mask:0xf
  v_cvt_pk_bf16_f32 v10, v10, v10
  v_and_b32 v10, s62, v10
  v_mul_f32 v10, s61, v10
  v_cvt_pk_bf16_f32 v10, v10, v10
  v_and_b32 v10, s62, v10
  ds_write_b32 v7, v10 offset:384
  s_waitcnt vmcnt(5)
  buffer_load_dwordx4 v[84:87], v1, s[4:7], s50 offen offset:0 nt
  s_waitcnt vmcnt(5)
  buffer_load_dwordx4 v[88:91], v1, s[4:7], s50 offen offset:128 nt
  s_waitcnt vmcnt(4)
  buffer_load_dwordx4 v[92:95], v1, s[4:7], s50 offen offset:256 nt
  s_add_u32 s50, s50, 393216
  v_mfma_f32_16x16x32_bf16 v[12:15], v[96:99], v[24:27], 0
  v_mfma_f32_16x16x32_bf16 v[12:15], v[100:103], v[28:31], v[12:15]
  v_mfma_f32_16x16x32_bf16 v[12:15], v[104:107], v[32:35], v[12:15]
  s_nop 7
  v_cndmask_b32 v10, v12, v13, s[56:57]
  v_cndmask_b32 v11, v14, v15, s[56:57]
  v_cndmask_b32 v10, v10, v11, s[58:59]
  s_nop 1
  v_add_f32_dpp v10, v10, v10 quad_perm:[1,0,3,2] row_mask:0xf bank_mask:0xf
  v_cvt_pk_bf16_f32 v10, v10, v10
  v_and_b32 v10, s62, v10
  v_mul_f32 v10, s61, v10
  v_cvt_pk_bf16_f32 v10, v10, v10
  v_and_b32 v10, s62, v10
  ds_write_b32 v7, v10 offset:512
  s_waitcnt vmcnt(5)
  buffer_load_dwordx4 v[96:99], v1, s[4:7], s50 offen offset:0 nt
  s_waitcnt vmcnt(5)
  buffer_load_dwordx4 v[100:103], v1, s[4:7], s50 offen offset:128 nt
  s_waitcnt vmcnt(4)
  buffer_load_dwordx4 v[104:107], v1, s[4:7], s50 offen offset:256 nt
  s_add_u32 s50, s50, 393216
  v_mfma_f32_16x16x32_bf16 v[12:15], v[108:111], v[24:27], 0
  v_mfma_f32_16x16x32_bf16 v[12:15], v[112:115], v[28:31], v[12:15]
  v_mfma_f32_16x16x32_bf16 v[12:15], v[116:119], v[32:35], v[12:15]
  s_nop 7
  v_cndmask_b32 v10, v12, v13, s[56:57]
  v_cndmask_b32 v11, v14, v15, s[56:57]
  v_cndmask_b32 v10, v10, v11, s[58:59]
  s_nop 1
  v_add_f32_dpp v10, v10, v10 quad_perm:[1,0,3,2] row_mask:0xf bank_mask:0xf
  v_cvt_pk_bf16_f32 v10, v10, v10
  v_and_b32 v10, s62, v10
  v_mul_f32 v10, s61, v10
  v_cvt_pk_bf16_f32 v10, v10, v10
  v_and_b32 v10, s62, v10
  ds_write_b32 v7, v10 offset:640
  s_waitcnt vmcnt(5)
  buffer_load_dwordx4 v[108:111], v1, s[4:7], s50 offen offset:0 nt
  s_waitcnt vmcnt(5)
  buffer_load_dwordx4 v[112:115], v1, s[4:7], s50 offen offset:128 nt
  s_waitcnt vmcnt(4)
  buffer_load_dwordx4 v[116:119], v1, s[4:7], s50 offen offset:256 nt
  s_add_u32 s50, s50, 393216
  v_mfma_f32_16x16x32_bf16 v[12:15], v[120:123], v[24:27], 0
  v_mfma_f32_16x16x32_bf16 v[12:15], v[124:127], v[28:31], v[12:15]
  v_mfma_f32_16x16x32_bf16 v[12:15], v[128:131], v[32:35], v[12:15]
  s_nop 7
  v_cndmask_b32 v10, v12, v13, s[56:57]
  v_cndmask_b32 v11, v14, v15, s[56:57]
  v_cndmask_b32 v10, v10, v11, s[58:59]
  s_nop 1
  v_add_f32_dpp v10, v10, v10 quad_perm:[1,0,3,2] row_mask:0xf bank_mask:0xf
  v_cvt_pk_bf16_f32 v10, v10, v10
  v_and_b32 v10, s62, v10
  v_mul_f32 v10, s61, v10
  v_cvt_pk_bf16_f32 v10, v10, v10
  v_and_b32 v10, s62, v10
  ds_write_b32 v7, v10 offset:768
  s_waitcnt vmcnt(5)
  buffer_load_dwordx4 v[120:123], v1, s[4:7], s50 offen offset:0 nt
  s_waitcnt vmcnt(5)
  buffer_load_dwordx4 v[124:127], v1, s[4:7], s50 offen offset:128 nt
  s_waitcnt vmcnt(4)
  buffer_load_dwordx4 v[128:131], v1, s[4:7], s50 offen offset:256 nt
  s_add_u32 s50, s50, 393216
  v_mfma_f32_16x16x32_bf16 v[12:15], v[132:135], v[24:27], 0
  v_mfma_f32_16x16x32_bf16 v[12:15], v[136:139], v[28:31], v[12:15]
  v_mfma_f32_16x16x32_bf16 v[12:15], v[140:143], v[32:35], v[12:15]
  s_nop 7
  v_cndmask_b32 v10, v12, v13, s[56:57]
  v_cndmask_b32 v11, v14, v15, s[56:57]
  v_cndmask_b32 v10, v10, v11, s[58:59]
  s_nop 1
  v_add_f32_dpp v10, v10, v10 quad_perm:[1,0,3,2] row_mask:0xf bank_mask:0xf
  v_cvt_pk_bf16_f32 v10, v10, v10
  v_and_b32 v10, s62, v10
  v_mul_f32 v10, s61, v10
  v_cvt_pk_bf16_f32 v10, v10, v10
  v_and_b32 v10, s62, v10
  ds_write_b32 v7, v10 offset:896
  v_add_u32 v7, 1024, v7
  s_mov_b32 s51, 3
  .p2align 6
L_k:
  s_waitcnt vmcnt(5)
  buffer_load_dwordx4 v[132:135], v1, s[4:7], s50 offen offset:0 nt
  s_waitcnt vmcnt(5)
  buffer_load_dwordx4 v[136:139], v1, s[4:7], s50 offen offset:128 nt
  s_waitcnt vmcnt(4)
  buffer_load_dwordx4 v[140:143], v1, s[4:7], s50 offen offset:256 nt
  s_add_u32 s50, s50, 393216
  s_waitcnt lgkmcnt(0)
  v_mfma_f32_16x16x32_bf16 v[12:15], v[48:51], v[24:27], 0
  v_mfma_f32_16x16x32_bf16 v[12:15], v[52:55], v[28:31], v[12:15]
  v_mfma_f32_16x16x32_bf16 v[12:15], v[56:59], v[32:35], v[12:15]
  s_nop 7
  v_cndmask_b32 v10, v12, v13, s[56:57]
  v_cndmask_b32 v11, v14, v15, s[56:57]
  v_cndmask_b32 v10, v10, v11, s[58:59]
  s_nop 1
  v_add_f32_dpp v10, v10, v10 quad_perm:[1,0,3,2] row_mask:0xf bank_mask:0xf
  v_cvt_pk_bf16_f32 v10, v10, v10
  v_and_b32 v10, s62, v10
  v_mul_f32 v10, s61, v10
  v_cvt_pk_bf16_f32 v10, v10, v10
  v_and_b32 v10, s62, v10
  ds_write_b32 v7, v10 offset:0
  s_and_b32 s63, s51, 3
  s_cmp_eq_u32 s63, 3
  s_cselect_b32 s63, 88080384, 0
  s_cmp_eq_u32 s51, 11
  s_cselect_b32 s63, s98, s63
  s_add_u32 s50, s50, s63
  s_waitcnt vmcnt(5)
  buffer_load_dwordx4 v[48:51], v1, s[4:7], s50 offen offset:0 nt
  s_waitcnt vmcnt(5)
  buffer_load_dwordx4 v[52:55], v1, s[4:7], s50 offen offset:128 nt
  s_waitcnt vmcnt(4)
  buffer_load_dwordx4 v[56:59], v1, s[4:7], s50 offen offset:256 nt
  s_add_u32 s50, s50, 393216
  v_mfma_f32_16x16x32_bf16 v[12:15], v[60:63], v[24:27], 0
  v_mfma_f32_16x16x32_bf16 v[12:15], v[64:67], v[28:31], v[12:15]
  v_mfma_f32_16x16x32_bf16 v[12:15], v[68:71], v[32:35], v[12:15]
  s_nop 7
  v_cndmask_b32 v10, v12, v13, s[56:57]
  v_cndmask_b32 v11, v14, v15, s[56:57]
  v_cndmask_b32 v10, v10, v11, s[58:59]
  s_nop 1
  v_add_f32_dpp v10, v10, v10 quad_perm:[1,0,3,2] row_mask:0xf bank_mask:0xf
  v_cvt_pk_bf16_f32 v10, v10, v10
  v_and_b32 v10, s62, v10
  v_mul_f32 v10, s61, v10
  v_cvt_pk_bf16_f32 v10, v10, v10
  v_and_b32 v10, s62, v10
  ds_write_b32 v7, v10 offset:128
  s_waitcnt vmcnt(5)
  buffer_load_dwordx4 v[60:63], v1, s[4:7], s50 offen offset:0 nt
  s_waitcnt vmcnt(5)
  buffer_load_dwordx4 v[64:67], v1, s[4:7], s50 offen offset:128 nt
  s_waitcnt vmcnt(4)
  buffer_load_dwordx4 v[68:71], v1, s[4:7], s50 offen offset:256 nt
  s_add_u32 s50, s50, 393216
  v_mfma_f32_16x16x32_bf16 v[12:15], v[72:75], v[24:27], 0
  v_mfma_f32_16x16x32_bf16 v[12:15], v[76:79], v[28:31], v[12:15]
  v_mfma_f32_16x16x32_bf16 v[12:15], v[80:83], v[32:35], v[12:15]
  s_nop 7
  v_cndmask_b32 v10, v12, v13, s[56:57]
  v_cndmask_b32 v11, v14, v15, s[56:57]
  v_cndmask_b32 v10, v10, v11, s[58:59]
  s_nop 1
  v_add_f32_dpp v10, v10, v10 quad_perm:[1,0,3,2] row_mask:0xf bank_mask:0xf
  v_cvt_pk_bf16_f32 v10, v10, v10
  v_and_b32 v10, s62, v10
  v_mul_f32 v10, s61, v10
  v_cvt_pk_bf16_f32 v10, v10, v10
  v_and_b32 v10, s62, v10
  ds_write_b32 v7, v10 offset:256
  s_waitcnt vmcnt(5)
  buffer_load_dwordx4 v[72:75], v1, s[4:7], s50 offen offset:0 nt
  s_waitcnt vmcnt(5)
  buffer_load_dwordx4 v[76:79], v1, s[4:7], s50 offen offset:128 nt
  s_waitcnt vmcnt(4)
  buffer_load_dwordx4 v[80:83], v1, s[4:7], s50 offen offset:256 nt
  s_add_u32 s50, s50, 393216
  v_mfma_f32_16x16x32_bf16 v[12:15], v[84:87], v[24:27], 0
  v_mfma_f32_16x16x32_bf16 v[12:15], v[88:91], v[28:31], v[12:15]
  v_mfma_f32_16x16x32_bf16 v[12:15], v[92:95], v[32:35], v[12:15]
  s_nop 7
  v_cndmask_b32 v10, v12, v13, s[56:57]
  v_cndmask_b32 v11, v14, v15, s[56:57]
  v_cndmask_b32 v10, v10, v11, s[58:59]
  s_nop 1
  v_add_f32_dpp v10, v10, v10 quad_perm:[1,0,3,2] row_mask:0xf bank_mask:0xf
  v_cvt_pk_bf16_f32 v10, v10, v10
  v_and_b32 v10, s62, v10
  v_mul_f32 v10, s61, v10
  v_cvt_pk_bf16_f32 v10, v10, v10
  v_and_b32 v10, s62, v10
  ds_write_b32 v7, v10 offset:384
  s_waitcnt vmcnt(5)
  buffer_load_dwordx4 v[84:87], v1, s[4:7], s50 offen offset:0 nt
  s_waitcnt vmcnt(5)
  buffer_load_dwordx4 v[88:91], v1, s[4:7], s50 offen offset:128 nt
  s_waitcnt vmcnt(4)
  buffer_load_dwordx4 v[92:95], v1, s[4:7], s50 offen offset:256 nt
  s_add_u32 s50, s50, 393216
  v_mfma_f32_16x16x32_bf16 v[12:15], v[96:99], v[24:27], 0
  v_mfma_f32_16x16x32_bf16 v[12:15], v[100:103], v[28:31], v[12:15]
  v_mfma_f32_16x16x32_bf16 v[12:15], v[104:107], v[32:35], v[12:15]
  s_nop 7
  v_cndmask_b32 v10, v12, v13, s[56:57]
  v_cndmask_b32 v11, v14, v15, s[56:57]
  v_cndmask_b32 v10, v10, v11, s[58:59]
  s_nop 1
  v_add_f32_dpp v10, v10, v10 quad_perm:[1,0,3,2] row_mask:0xf bank_mask:0xf
  v_cvt_pk_bf16_f32 v10, v10, v10
  v_and_b32 v10, s62, v10
  v_mul_f32 v10, s61, v10
  v_cvt_pk_bf16_f32 v10, v10, v10
  v_and_b32 v10, s62, v10
  ds_write_b32 v7, v10 offset:512
  s_waitcnt vmcnt(5)
  buffer_load_dwordx4 v[96:99], v1, s[4:7], s50 offen offset:0 nt
  s_waitcnt vmcnt(5)
  buffer_load_dwordx4 v[100:103], v1, s[4:7], s50 offen offset:128 nt
  s_waitcnt vmcnt(4)
  buffer_load_dwordx4 v[104:107], v1, s[4:7], s50 offen offset:256 nt
  s_add_u32 s50, s50, 393216
  v_mfma_f32_16x16x32_bf16 v[12:15], v[108:111], v[24:27], 0
  v_mfma_f32_16x16x32_bf16 v[12:15], v[112:115], v[28:31], v[12:15]
  v_mfma_f32_16x16x32_bf16 v[12:15], v[116:119], v[32:35], v[12:15]
  s_nop 7
  v_cndmask_b32 v10, v12, v13, s[56:57]
  v_cndmask_b32 v11, v14, v15, s[56:57]
  v_cndmask_b32 v10, v10, v11, s[58:59]
  s_nop 1
  v_add_f32_dpp v10, v10, v10 quad_perm:[1,0,3,2] row_mask:0xf bank_mask:0xf
  v_cvt_pk_bf16_f32 v10, v10, v10
  v_and_b32 v10, s62, v10
  v_mul_f32 v10, s61, v10
  v_cvt_pk_bf16_f32 v10, v10, v10
  v_and_b32 v10, s62, v10
  ds_write_b32 v7, v10 offset:640
  s_waitcnt vmcnt(5)
  buffer_load_dwordx4 v[108:111], v1, s[4:7], s50 offen offset:0 nt
  s_waitcnt vmcnt(5)
  buffer_load_dwordx4 v[112:115], v1, s[4:7], s50 offen offset:128 nt
  s_waitcnt vmcnt(4)
  buffer_load_dwordx4 v[116:119], v1, s[4:7], s50 offen offset:256 nt
  s_add_u32 s50, s50, 393216
  v_mfma_f32_16x16x32_bf16 v[12:15], v[120:123], v[24:27], 0
  v_mfma_f32_16x16x32_bf16 v[12:15], v[124:127], v[28:31], v[12:15]
  v_mfma_f32_16x16x32_bf16 v[12:15], v[128:131], v[32:35], v[12:15]
  s_nop 7
  v_cndmask_b32 v10, v12, v13, s[56:57]
  v_cndmask_b32 v11, v14, v15, s[56:57]
  v_cndmask_b32 v10, v10, v11, s[58:59]
  s_nop 1
  v_add_f32_dpp v10, v10, v10 quad_perm:[1,0,3,2] row_mask:0xf bank_mask:0xf
  v_cvt_pk_bf16_f32 v10, v10, v10
  v_and_b32 v10, s62, v10
  v_mul_f32 v10, s61, v10
  v_cvt_pk_bf16_f32 v10, v10, v10
  v_and_b32 v10, s62, v10
  ds_write_b32 v7, v10 offset:768
  s_waitcnt vmcnt(5)
  buffer_load_dwordx4 v[120:123], v1, s[4:7], s50 offen offset:0 nt
  s_waitcnt vmcnt(5)
  buffer_load_dwordx4 v[124:127], v1, s[4:7], s50 offen offset:128 nt
  s_waitcnt vmcnt(4)
  buffer_load_dwordx4 v[128:131], v1, s[4:7], s50 offen offset:256 nt
  s_add_u32 s50, s50, 393216
  v_mfma_f32_16x16x32_bf16 v[12:15], v[132:135], v[24:27], 0
  v_mfma_f32_16x16x32_bf16 v[12:15], v[136:139], v[28:31], v[12:15]
  v_mfma_f32_16x16x32_bf16 v[12:15], v[140:143], v[32:35], v[12:15]
  s_nop 7
  v_cndmask_b32 v10, v12, v13, s[56:57]
  v_cndmask_b32 v11, v14, v15, s[56:57]
  v_cndmask_b32 v10, v10, v11, s[58:59]
  s_nop 1
  v_add_f32_dpp v10, v10, v10 quad_perm:[1,0,3,2] row_mask:0xf bank_mask:0xf
  v_cvt_pk_bf16_f32 v10, v10, v10
  v_and_b32 v10, s62, v10
  v_mul_f32 v10, s61, v10
  v_cvt_pk_bf16_f32 v10, v10, v10
  v_and_b32 v10, s62, v10
  ds_write_b32 v7, v10 offset:896
  v_add_u32 v7, 1024, v7
  s_add_u32 s51, s51, 1
  s_and_b32 s63, s51, 3
  s_cbranch_scc1 L_k_c
  s_mov_b64 exec, 1
  ds_add_u32 v150, v148 offset:0
  s_mov_b64 exec, -1
  v_add_u32 v150, 4, v150
  ds_read_b128 v[24:27], v149 offset:0
  ds_read_b128 v[28:31], v149 offset:128
  ds_read_b128 v[32:35], v149 offset:256
  v_add_u32 v149, 384, v149
L_k_c:
  s_cmp_lt_u32 s51, 15
  s_cbranch_scc1 L_k
  s_waitcnt vmcnt(5)
  buffer_load_dwordx4 v[132:135], v1, s[4:7], s50 offen offset:0 nt
  s_waitcnt vmcnt(5)
  buffer_load_dwordx4 v[136:139], v1, s[4:7], s50 offen offset:128 nt
  s_waitcnt vmcnt(4)
  buffer_load_dwordx4 v[140:143], v1, s[4:7], s50 offen offset:256 nt
  s_add_u32 s50, s50, 393216
  v_mfma_f32_16x16x32_bf16 v[12:15], v[48:51], v[24:27], 0
  v_mfma_f32_16x16x32_bf16 v[12:15], v[52:55], v[28:31], v[12:15]
  v_mfma_f32_16x16x32_bf16 v[12:15], v[56:59], v[32:35], v[12:15]
  s_nop 7
  v_cndmask_b32 v10, v12, v13, s[56:57]
  v_cndmask_b32 v11, v14, v15, s[56:57]
  v_cndmask_b32 v10, v10, v11, s[58:59]
  s_nop 1
  v_add_f32_dpp v10, v10, v10 quad_perm:[1,0,3,2] row_mask:0xf bank_mask:0xf
  v_cvt_pk_bf16_f32 v10, v10, v10
  v_and_b32 v10, s62, v10
  v_mul_f32 v10, s61, v10
  v_cvt_pk_bf16_f32 v10, v10, v10
  v_and_b32 v10, s62, v10
  ds_write_b32 v7, v10 offset:0
  s_mov_b32 s50, s75
  s_waitcnt vmcnt(5)
  buffer_load_dwordx4 v[48:51], v2, s[8:11], s50 offen offset:0 nt
  s_waitcnt vmcnt(5)
  buffer_load_dwordx4 v[52:55], v2, s[8:11], s50 offen offset:256 nt
  s_waitcnt vmcnt(5)
  buffer_load_dwordx4 v[56:59], v2, s[8:11], s50 offen offset:512 nt
  s_add_u32 s50, s50, 393216
  v_mfma_f32_16x16x32_bf16 v[12:15], v[60:63], v[24:27], 0
  v_mfma_f32_16x16x32_bf16 v[12:15], v[64:67], v[28:31], v[12:15]
  v_mfma_f32_16x16x32_bf16 v[12:15], v[68:71], v[32:35], v[12:15]
  s_nop 7
  v_cndmask_b32 v10, v12, v13, s[56:57]
  v_cndmask_b32 v11, v14, v15, s[56:57]
  v_cndmask_b32 v10, v10, v11, s[58:59]
  s_nop 1
  v_add_f32_dpp v10, v10, v10 quad_perm:[1,0,3,2] row_mask:0xf bank_mask:0xf
  v_cvt_pk_bf16_f32 v10, v10, v10
  v_and_b32 v10, s62, v10
  v_mul_f32 v10, s61, v10
  v_cvt_pk_bf16_f32 v10, v10, v10
  v_and_b32 v10, s62, v10
  ds_write_b32 v7, v10 offset:128
  s_waitcnt vmcnt(5)
  buffer_load_dwordx4 v[60:63], v2, s[8:11], s50 offen offset:0 nt
  s_waitcnt vmcnt(5)
  buffer_load_dwordx4 v[64:67], v2, s[8:11], s50 offen offset:256 nt
  s_waitcnt vmcnt(5)
  buffer_load_dwordx4 v[68:71], v2, s[8:11], s50 offen offset:512 nt
  s_add_u32 s50, s50, 393216
  v_mfma_f32_16x16x32_bf16 v[12:15], v[72:75], v[24:27], 0
  v_mfma_f32_16x16x32_bf16 v[12:15], v[76:79], v[28:31], v[12:15]
  v_mfma_f32_16x16x32_bf16 v[12:15], v[80:83], v[32:35], v[12:15]
  s_nop 7
  v_cndmask_b32 v10, v12, v13, s[56:57]
  v_cndmask_b32 v11, v14, v15, s[56:57]
  v_cndmask_b32 v10, v10, v11, s[58:59]
  s_nop 1
  v_add_f32_dpp v10, v10, v10 quad_perm:[1,0,3,2] row_mask:0xf bank_mask:0xf
  v_cvt_pk_bf16_f32 v10, v10, v10
  v_and_b32 v10, s62, v10
  v_mul_f32 v10, s61, v10
  v_cvt_pk_bf16_f32 v10, v10, v10
  v_and_b32 v10, s62, v10
  ds_write_b32 v7, v10 offset:256
  s_waitcnt vmcnt(12)
  v_mfma_f32_16x16x32_bf16 v[12:15], v[84:87], v[24:27], 0
  v_mfma_f32_16x16x32_bf16 v[12:15], v[88:91], v[28:31], v[12:15]
  v_mfma_f32_16x16x32_bf16 v[12:15], v[92:95], v[32:35], v[12:15]
  s_nop 7
  v_cndmask_b32 v10, v12, v13, s[56:57]
  v_cndmask_b32 v11, v14, v15, s[56:57]
  v_cndmask_b32 v10, v10, v11, s[58:59]
  s_nop 1
  v_add_f32_dpp v10, v10, v10 quad_perm:[1,0,3,2] row_mask:0xf bank_mask:0xf
  v_cvt_pk_bf16_f32 v10, v10, v10
  v_and_b32 v10, s62, v10
  v_mul_f32 v10, s61, v10
  v_cvt_pk_bf16_f32 v10, v10, v10
  v_and_b32 v10, s62, v10
  ds_write_b32 v7, v10 offset:384
  s_waitcnt vmcnt(5)
  buffer_load_dwordx4 v[72:75], v2, s[8:11], s50 offen offset:0 nt
  s_waitcnt vmcnt(5)
  buffer_load_dwordx4 v[76:79], v2, s[8:11], s50 offen offset:256 nt
  s_waitcnt vmcnt(5)
  buffer_load_dwordx4 v[80:83], v2, s[8:11], s50 offen offset:512 nt
  s_add_u32 s50, s50, 393216
  v_mfma_f32_16x16x32_bf16 v[12:15], v[96:99], v[24:27], 0
  v_mfma_f32_16x16x32_bf16 v[12:15], v[100:103], v[28:31], v[12:15]
  v_mfma_f32_16x16x32_bf16 v[12:15], v[104:107], v[32:35], v[12:15]
  s_nop 7
  v_cndmask_b32 v10, v12, v13, s[56:57]
  v_cndmask_b32 v11, v14, v15, s[56:57]
  v_cndmask_b32 v10, v10, v11, s[58:59]
  s_nop 1
  v_add_f32_dpp v10, v10, v10 quad_perm:[1,0,3,2] row_mask:0xf bank_mask:0xf
  v_cvt_pk_bf16_f32 v10, v10, v10
  v_and_b32 v10, s62, v10
  v_mul_f32 v10, s61, v10
  v_cvt_pk_bf16_f32 v10, v10, v10
  v_and_b32 v10, s62, v10
  ds_write_b32 v7, v10 offset:512
  s_waitcnt vmcnt(12)
  v_mfma_f32_16x16x32_bf16 v[12:15], v[108:111], v[24:27], 0
  v_mfma_f32_16x16x32_bf16 v[12:15], v[112:115], v[28:31], v[12:15]
  v_mfma_f32_16x16x32_bf16 v[12:15], v[116:119], v[32:35], v[12:15]
  s_nop 7
  v_cndmask_b32 v10, v12, v13, s[56:57]
  v_cndmask_b32 v11, v14, v15, s[56:57]
  v_cndmask_b32 v10, v10, v11, s[58:59]
  s_nop 1
  v_add_f32_dpp v10, v10, v10 quad_perm:[1,0,3,2] row_mask:0xf bank_mask:0xf
  v_cvt_pk_bf16_f32 v10, v10, v10
  v_and_b32 v10, s62, v10
  v_mul_f32 v10, s61, v10
  v_cvt_pk_bf16_f32 v10, v10, v10
  v_and_b32 v10, s62, v10
  ds_write_b32 v7, v10 offset:640
  s_waitcnt vmcnt(5)
  buffer_load_dwordx4 v[84:87], v2, s[8:11], s50 offen offset:0 nt
  s_waitcnt vmcnt(5)
  buffer_load_dwordx4 v[88:91], v2, s[8:11], s50 offen offset:256 nt
  s_waitcnt vmcnt(5)
  buffer_load_dwordx4 v[92:95], v2, s[8:11], s50 offen offset:512 nt
  s_add_u32 s50, s50, 393216
  v_mfma_f32_16x16x32_bf16 v[12:15], v[120:123], v[24:27], 0
  v_mfma_f32_16x16x32_bf16 v[12:15], v[124:127], v[28:31], v[12:15]
  v_mfma_f32_16x16x32_bf16 v[12:15], v[128:131], v[32:35], v[12:15]
  s_nop 7
  v_cndmask_b32 v10, v12, v13, s[56:57]
  v_cndmask_b32 v11, v14, v15, s[56:57]
  v_cndmask_b32 v10, v10, v11, s[58:59]
  s_nop 1
  v_add_f32_dpp v10, v10, v10 quad_perm:[1,0,3,2] row_mask:0xf bank_mask:0xf
  v_cvt_pk_bf16_f32 v10, v10, v10
  v_and_b32 v10, s62, v10
  v_mul_f32 v10, s61, v10
  v_cvt_pk_bf16_f32 v10, v10, v10
  v_and_b32 v10, s62, v10
  ds_write_b32 v7, v10 offset:768
  s_waitcnt vmcnt(12)
  v_mfma_f32_16x16x32_bf16 v[12:15], v[132:135], v[24:27], 0
  v_mfma_f32_16x16x32_bf16 v[12:15], v[136:139], v[28:31], v[12:15]
  v_mfma_f32_16x16x32_bf16 v[12:15], v[140:143], v[32:35], v[12:15]
  s_nop 7
  v_cndmask_b32 v10, v12, v13, s[56:57]
  v_cndmask_b32 v11, v14, v15, s[56:57]
  v_cndmask_b32 v10, v10, v11, s[58:59]
  s_nop 1
  v_add_f32_dpp v10, v10, v10 quad_perm:[1,0,3,2] row_mask:0xf bank_mask:0xf
  v_cvt_pk_bf16_f32 v10, v10, v10
  v_and_b32 v10, s62, v10
  v_mul_f32 v10, s61, v10
  v_cvt_pk_bf16_f32 v10, v10, v10
  v_and_b32 v10, s62, v10
  ds_write_b32 v7, v10 offset:896
  s_mov_b64 exec, 1
  ds_add_u32 v150, v148 offset:0
  s_mov_b64 exec, -1
  v_subrev_u32 v7, 15360, v7
  v_mov_b32 v150, v147
  s_mov_b32 s51, 0
  v_mov_b32 v151, 6144
  v_cmp_le_u32 vcc, 8192, v144
  s_nop 1
  v_cndmask_b32 v10, 0, v151, vcc
  v_sub_u32 v144, v144, v10
  v_cmp_le_u32 vcc, 8192, v145
  s_nop 1
  v_cndmask_b32 v10, 0, v151, vcc
  v_sub_u32 v145, v145, v10
  v_cmp_le_u32 vcc, 8192, v146
  s_nop 1
  v_cndmask_b32 v10, 0, v151, vcc
  v_sub_u32 v146, v146, v10
  .p2align 6
L_v:
  ds_read_b32 v9, v150 offset:16
  ds_read_b32 v24, v7 offset:0
  ds_read_b32 v25, v7 offset:128
  ds_read_b32 v26, v7 offset:256
  ds_read_b32 v27, v7 offset:384
  ds_read_b32 v28, v7 offset:512
  ds_read_b32 v29, v7 offset:640
  ds_read_b32 v30, v7 offset:768
  ds_read_b32 v31, v7 offset:896
  s_waitcnt vmcnt(5)
  buffer_load_dwordx4 v[96:99], v2, s[8:11], s50 offen offset:0 nt
  s_waitcnt vmcnt(5)
  buffer_load_dwordx4 v[100:103], v2, s[8:11], s50 offen offset:256 nt
  s_waitcnt vmcnt(5)
  buffer_load_dwordx4 v[104:107], v2, s[8:11], s50 offen offset:512 nt
  s_add_u32 s50, s50, 393216
  s_waitcnt lgkmcnt(0)
  v_readfirstlane_b32 s63, v9
  s_nop 0
  s_cmp_eq_u32 s63, 0
  s_cbranch_scc1 L_slowv0
L_backv0:
  v_add_u32 v7, 1024, v7
  s_and_b32 s63, s51, 3
  s_cbranch_scc1 L_nzv0
  v_cmp_le_u32 vcc, 8192, v144
  s_nop 1
  v_cndmask_b32 v10, 0, v151, vcc
  v_add_u32 v144, v144, v10
  v_cmp_le_u32 vcc, 8192, v145
  s_nop 1
  v_cndmask_b32 v10, 0, v151, vcc
  v_add_u32 v145, v145, v10
  v_cmp_le_u32 vcc, 8192, v146
  s_nop 1
  v_cndmask_b32 v10, 0, v151, vcc
  v_add_u32 v146, v146, v10
  v_mov_b32 v36, 0
  v_mov_b32 v37, 0
  v_mov_b32 v38, 0
  v_mov_b32 v39, 0
  v_mov_b32 v40, 0
  v_mov_b32 v41, 0
  v_mov_b32 v42, 0
  v_mov_b32 v43, 0
  v_mov_b32 v44, 0
  v_mov_b32 v45, 0
  v_mov_b32 v46, 0
  v_mov_b32 v47, 0
L_nzv0:
  v_and_b32 v16, v24, v3
  v_and_b32 v17, v24, v4
  v_and_b32 v18, v24, v5
  v_and_b32 v19, v24, v6
  s_nop 1
  v_mfma_f32_16x16x32_bf16 v[36:39], v[16:19], v[48:51], v[36:39]
  v_mfma_f32_16x16x32_bf16 v[40:43], v[16:19], v[52:55], v[40:43]
  v_mfma_f32_16x16x32_bf16 v[44:47], v[16:19], v[56:59], v[44:47]
  s_waitcnt vmcnt(5)
  buffer_load_dwordx4 v[108:111], v2, s[8:11], s50 offen offset:0 nt
  s_waitcnt vmcnt(5)
  buffer_load_dwordx4 v[112:115], v2, s[8:11], s50 offen offset:256 nt
  s_waitcnt vmcnt(5)
  buffer_load_dwordx4 v[116:119], v2, s[8:11], s50 offen offset:512 nt
  s_add_u32 s50, s50, 393216
  v_and_b32 v16, v25, v3
  v_and_b32 v17, v25, v4
  v_and_b32 v18, v25, v5
  v_and_b32 v19, v25, v6
  s_nop 1
  v_mfma_f32_16x16x32_bf16 v[36:39], v[16:19], v[60:63], v[36:39]
  v_mfma_f32_16x16x32_bf16 v[40:43], v[16:19], v[64:67], v[40:43]
  v_mfma_f32_16x16x32_bf16 v[44:47], v[16:19], v[68:71], v[44:47]
  s_waitcnt vmcnt(5)
  buffer_load_dwordx4 v[120:123], v2, s[8:11], s50 offen offset:0 nt
  s_waitcnt vmcnt(5)
  buffer_load_dwordx4 v[124:127], v2, s[8:11], s50 offen offset:256 nt
  s_waitcnt vmcnt(5)
  buffer_load_dwordx4 v[128:131], v2, s[8:11], s50 offen offset:512 nt
  s_add_u32 s50, s50, 393216
  v_and_b32 v16, v26, v3
  v_and_b32 v17, v26, v4
  v_and_b32 v18, v26, v5
  v_and_b32 v19, v26, v6
  s_nop 1
  v_mfma_f32_16x16x32_bf16 v[36:39], v[16:19], v[72:75], v[36:39]
  v_mfma_f32_16x16x32_bf16 v[40:43], v[16:19], v[76:79], v[40:43]
  v_mfma_f32_16x16x32_bf16 v[44:47], v[16:19], v[80:83], v[44:47]
  s_waitcnt vmcnt(5)
  buffer_load_dwordx4 v[132:135], v2, s[8:11], s50 offen offset:0 nt
  s_waitcnt vmcnt(5)
  buffer_load_dwordx4 v[136:139], v2, s[8:11], s50 offen offset:256 nt
  s_waitcnt vmcnt(5)
  buffer_load_dwordx4 v[140:143], v2, s[8:11], s50 offen offset:512 nt
  s_add_u32 s50, s50, 393216
  v_and_b32 v16, v27, v3
  v_and_b32 v17, v27, v4
  v_and_b32 v18, v27, v5
  v_and_b32 v19, v27, v6
  s_nop 1
  v_mfma_f32_16x16x32_bf16 v[36:39], v[16:19], v[84:87], v[36:39]
  v_mfma_f32_16x16x32_bf16 v[40:43], v[16:19], v[88:91], v[40:43]
  v_mfma_f32_16x16x32_bf16 v[44:47], v[16:19], v[92:95], v[44:47]
  s_and_b32 s63, s51, 3
  s_cmp_eq_u32 s63, 3
  s_cselect_b32 s63, 88080384, 0
  s_cmp_eq_u32 s51, 11
  s_cselect_b32 s63, s98, s63
  s_add_u32 s50, s50, s63
  s_waitcnt vmcnt(5)
  buffer_load_dwordx4 v[48:51], v2, s[8:11], s50 offen offset:0 nt
  s_waitcnt vmcnt(5)
  buffer_load_dwordx4 v[52:55], v2, s[8:11], s50 offen offset:256 nt
  s_waitcnt vmcnt(5)
  buffer_load_dwordx4 v[56:59], v2, s[8:11], s50 offen offset:512 nt
  s_add_u32 s50, s50, 393216
  v_and_b32 v16, v28, v3
  v_and_b32 v17, v28, v4
  v_and_b32 v18, v28, v5
  v_and_b32 v19, v28, v6
  s_nop 1
  v_mfma_f32_16x16x32_bf16 v[36:39], v[16:19], v[96:99], v[36:39]
  v_mfma_f32_16x16x32_bf16 v[40:43], v[16:19], v[100:103], v[40:43]
  v_mfma_f32_16x16x32_bf16 v[44:47], v[16:19], v[104:107], v[44:47]
  s_waitcnt vmcnt(5)
  buffer_load_dwordx4 v[60:63], v2, s[8:11], s50 offen offset:0 nt
  s_waitcnt vmcnt(5)
  buffer_load_dwordx4 v[64:67], v2, s[8:11], s50 offen offset:256 nt
  s_waitcnt vmcnt(5)
  buffer_load_dwordx4 v[68:71], v2, s[8:11], s50 offen offset:512 nt
  s_add_u32 s50, s50, 393216
  v_and_b32 v16, v29, v3
  v_and_b32 v17, v29, v4
  v_and_b32 v18, v29, v5
  v_and_b32 v19, v29, v6
  s_nop 1
  v_mfma_f32_16x16x32_bf16 v[36:39], v[16:19], v[108:111], v[36:39]
  v_mfma_f32_16x16x32_bf16 v[40:43], v[16:19], v[112:115], v[40:43]
  v_mfma_f32_16x16x32_bf16 v[44:47], v[16:19], v[116:119], v[44:47]
  s_waitcnt vmcnt(5)
  buffer_load_dwordx4 v[72:75], v2, s[8:11], s50 offen offset:0 nt
  s_waitcnt vmcnt(5)
  buffer_load_dwordx4 v[76:79], v2, s[8:11], s50 offen offset:256 nt
  s_waitcnt vmcnt(5)
  buffer_load_dwordx4 v[80:83], v2, s[8:11], s50 offen offset:512 nt
  s_add_u32 s50, s50, 393216
  v_and_b32 v16, v30, v3
  v_and_b32 v17, v30, v4
  v_and_b32 v18, v30, v5
  v_and_b32 v19, v30, v6
  s_nop 1
  v_mfma_f32_16x16x32_bf16 v[36:39], v[16:19], v[120:123], v[36:39]
  v_mfma_f32_16x16x32_bf16 v[40:43], v[16:19], v[124:127], v[40:43]
  v_mfma_f32_16x16x32_bf16 v[44:47], v[16:19], v[128:131], v[44:47]
  s_waitcnt vmcnt(5)
  buffer_load_dwordx4 v[84:87], v2, s[8:11], s50 offen offset:0 nt
  s_waitcnt vmcnt(5)
  buffer_load_dwordx4 v[88:91], v2, s[8:11], s50 offen offset:256 nt
  s_waitcnt vmcnt(5)
  buffer_load_dwordx4 v[92:95], v2, s[8:11], s50 offen offset:512 nt
  s_add_u32 s50, s50, 393216
  v_and_b32 v16, v31, v3
  v_and_b32 v17, v31, v4
  v_and_b32 v18, v31, v5
  v_and_b32 v19, v31, v6
  s_nop 1
  v_mfma_f32_16x16x32_bf16 v[36:39], v[16:19], v[132:135], v[36:39]
  v_mfma_f32_16x16x32_bf16 v[40:43], v[16:19], v[136:139], v[40:43]
  v_mfma_f32_16x16x32_bf16 v[44:47], v[16:19], v[140:143], v[44:47]
  s_add_u32 s51, s51, 1
  s_and_b32 s63, s51, 3
  s_cbranch_scc1 L_v_c
  s_nop 2
  ds_write_b128 v144, v[36:39]
  ds_write_b128 v145, v[40:43]
  ds_write_b128 v146, v[44:47]
  s_mov_b64 exec, 1
  ds_add_u32 v150, v148 offset:32
  s_mov_b64 exec, -1
  v_add_u32 v150, 4, v150
L_v_c:
  s_cmp_lt_u32 s51, 13
  s_cbranch_scc1 L_v
  ds_read_b32 v9, v150 offset:16
  ds_read_b32 v20, v147 offset:56
  ds_read_b32 v21, v147 offset:72
  ds_read_b32 v24, v7 offset:0
  ds_read_b32 v25, v7 offset:128
  ds_read_b32 v26, v7 offset:256
  ds_read_b32 v27, v7 offset:384
  ds_read_b32 v28, v7 offset:512
  ds_read_b32 v29, v7 offset:640
  ds_read_b32 v30, v7 offset:768
  ds_read_b32 v31, v7 offset:896
  s_cmp_eq_u32 s49, 255
  s_cselect_b32 s99, 1000, -1
  s_mov_b32 s76, -1
  s_mov_b32 s78, 1000000
  s_mov_b32 s79, 0
  s_waitcnt vmcnt(5)
  buffer_load_dwordx4 v[96:99], v2, s[8:11], s50 offen offset:0 nt
  s_waitcnt vmcnt(5)
  buffer_load_dwordx4 v[100:103], v2, s[8:11], s50 offen offset:256 nt
  s_waitcnt vmcnt(5)
  buffer_load_dwordx4 v[104:107], v2, s[8:11], s50 offen offset:512 nt
  s_add_u32 s50, s50, 393216
  s_waitcnt lgkmcnt(0)
  v_min3_u32 v9, v9, v20, v21
  s_nop 0
  v_readfirstlane_b32 s63, v9
  s_nop 0
  s_cmp_eq_u32 s63, 0
  s_cbranch_scc1 L_slowd
L_backd:
  v_add_u32 v7, 1024, v7
  s_and_b32 s63, s51, 3
  s_cbranch_scc1 L_nzd
  v_cmp_le_u32 vcc, 8192, v144
  s_nop 1
  v_cndmask_b32 v10, 0, v151, vcc
  v_add_u32 v144, v144, v10
  v_cmp_le_u32 vcc, 8192, v145
  s_nop 1
  v_cndmask_b32 v10, 0, v151, vcc
  v_add_u32 v145, v145, v10
  v_cmp_le_u32 vcc, 8192, v146
  s_nop 1
  v_cndmask_b32 v10, 0, v151, vcc
  v_add_u32 v146, v146, v10
  v_mov_b32 v36, 0
  v_mov_b32 v37, 0
  v_mov_b32 v38, 0
  v_mov_b32 v39, 0
  v_mov_b32 v40, 0
  v_mov_b32 v41, 0
  v_mov_b32 v42, 0
  v_mov_b32 v43, 0
  v_mov_b32 v44, 0
  v_mov_b32 v45, 0
  v_mov_b32 v46, 0
  v_mov_b32 v47, 0
L_nzd:
  v_readfirstlane_b32 s63, v21
  s_nop 0
  s_cmp_eq_u32 s63, 256
  s_cselect_b32 s99, 1000, -1
  v_and_b32 v16, v24, v3
  v_and_b32 v17, v24, v4
  v_and_b32 v18, v24, v5
  v_and_b32 v19, v24, v6
  s_nop 1
  v_mfma_f32_16x16x32_bf16 v[36:39], v[16:19], v[48:51], v[36:39]
  v_mfma_f32_16x16x32_bf16 v[40:43], v[16:19], v[52:55], v[40:43]
  v_mfma_f32_16x16x32_bf16 v[44:47], v[16:19], v[56:59], v[44:47]
  s_waitcnt vmcnt(5)
  buffer_load_dwordx4 v[108:111], v2, s[8:11], s50 offen offset:0 nt
  s_waitcnt vmcnt(5)
  buffer_load_dwordx4 v[112:115], v2, s[8:11], s50 offen offset:256 nt
  s_waitcnt vmcnt(5)
  buffer_load_dwordx4 v[116:119], v2, s[8:11], s50 offen offset:512 nt
  s_add_u32 s50, s50, 393216
  v_and_b32 v16, v25, v3
  v_and_b32 v17, v25, v4
  v_and_b32 v18, v25, v5
  v_and_b32 v19, v25, v6
  s_nop 1
  v_mfma_f32_16x16x32_bf16 v[36:39], v[16:19], v[60:63], v[36:39]
  v_mfma_f32_16x16x32_bf16 v[40:43], v[16:19], v[64:67], v[40:43]
  v_mfma_f32_16x16x32_bf16 v[44:47], v[16:19], v[68:71], v[44:47]
  s_cmp_ge_i32 s76, s99
  s_mov_b32 s76, 32
  s_mov_b32 s77, s46
  s_cbranch_scc1 L_a27
  s_mov_b64 s[76:77], 1
  s_atomic_add_x2 s[76:77], s[44:45], s54 glc
L_a27:
  s_waitcnt vmcnt(5)
  buffer_load_dwordx4 v[120:123], v2, s[8:11], s50 offen offset:0 nt
  s_waitcnt vmcnt(5)
  buffer_load_dwordx4 v[124:127], v2, s[8:11], s50 offen offset:256 nt
  s_waitcnt vmcnt(5)
  buffer_load_dwordx4 v[128:131], v2, s[8:11], s50 offen offset:512 nt
  s_add_u32 s50, s50, 393216
  v_and_b32 v16, v26, v3
  v_and_b32 v17, v26, v4
  v_and_b32 v18, v26, v5
  v_and_b32 v19, v26, v6
  s_nop 1
  v_mfma_f32_16x16x32_bf16 v[36:39], v[16:19], v[72:75], v[36:39]
  v_mfma_f32_16x16x32_bf16 v[40:43], v[16:19], v[76:79], v[40:43]
  v_mfma_f32_16x16x32_bf16 v[44:47], v[16:19], v[80:83], v[44:47]
  s_waitcnt vmcnt(5)
  buffer_load_dwordx4 v[132:135], v2, s[8:11], s50 offen offset:0 nt
  s_waitcnt vmcnt(5)
  buffer_load_dwordx4 v[136:139], v2, s[8:11], s50 offen offset:256 nt
  s_waitcnt vmcnt(5)
  buffer_load_dwordx4 v[140:143], v2, s[8:11], s50 offen offset:512 nt
  s_add_u32 s50, s50, 393216
  v_and_b32 v16, v27, v3
  v_and_b32 v17, v27, v4
  v_and_b32 v18, v27, v5
  v_and_b32 v19, v27, v6
  s_nop 1
  v_mfma_f32_16x16x32_bf16 v[36:39], v[16:19], v[84:87], v[36:39]
  v_mfma_f32_16x16x32_bf16 v[40:43], v[16:19], v[88:91], v[40:43]
  v_mfma_f32_16x16x32_bf16 v[44:47], v[16:19], v[92:95], v[44:47]
  v_bfi_b32 v156, s62, v29, v28
  v_bfi_b32 v157, s62, v31, v30
  v_lshrrev_b32 v8, 1, v8
  s_mov_b32 s70, 0x01000100
  s_mov_b32 s71, 0x03020302
  s_mov_b64 exec, 1
  ds_add_u32 v147, v148 offset:44
  s_mov_b64 exec, -1
  s_mov_b32 s51, -1
  s_branch L_tk1
  .p2align 6
L_d:
L_tk0:
  s_waitcnt lgkmcnt(0)
  s_cmp_lg_u32 s77, s46
  s_cbranch_scc1 L_retry0
  s_cmp_ge_u32 s76, 25
  s_cbranch_scc1 L_db0
  s_lshl_b32 s63, s76, 4
  s_add_u32 s63, s63, s74
  s_mul_i32 s50, s63, 12288
  s_add_u32 s50, s50, s53
  s_and_b32 s64, s63, 31
  s_lshl_b32 s64, s64, 11
  s_lshr_b32 s63, s63, 5
  s_lshl_b32 s63, s63, 6
  s_add_u32 s63, s63, s64
  s_add_u32 s52, s63, s55
  buffer_load_dwordx2 v[156:157], v8, s[12:15], s52 offen sc1
  s_waitcnt vmcnt(6)
  buffer_load_dwordx4 v[96:99], v2, s[8:11], s50 offen offset:0 nt
  s_waitcnt vmcnt(5)
  buffer_load_dwordx4 v[100:103], v2, s[8:11], s50 offen offset:256 nt
  s_waitcnt vmcnt(5)
  buffer_load_dwordx4 v[104:107], v2, s[8:11], s50 offen offset:512 nt
  s_add_u32 s50, s50, 3072
  v_perm_b32 v10, v152, v152, s70
  v_and_b32 v16, v10, v3
  v_and_b32 v17, v10, v4
  v_and_b32 v18, v10, v5
  v_and_b32 v19, v10, v6
  s_nop 1
  v_mfma_f32_16x16x32_bf16 v[36:39], v[16:19], v[48:51], v[36:39]
  v_mfma_f32_16x16x32_bf16 v[40:43], v[16:19], v[52:55], v[40:43]
  v_mfma_f32_16x16x32_bf16 v[44:47], v[16:19], v[56:59], v[44:47]
  s_waitcnt vmcnt(6)
  buffer_load_dwordx4 v[108:111], v2, s[8:11], s50 offen offset:0 nt
  s_waitcnt vmcnt(5)
  buffer_load_dwordx4 v[112:115], v2, s[8:11], s50 offen offset:256 nt
  s_waitcnt vmcnt(5)
  buffer_load_dwordx4 v[116:119], v2, s[8:11], s50 offen offset:512 nt
  s_add_u32 s50, s50, 3072
  v_perm_b32 v10, v152, v152, s71
  v_and_b32 v16, v10, v3
  v_and_b32 v17, v10, v4
  v_and_b32 v18, v10, v5
  v_and_b32 v19, v10, v6
  s_nop 1
  v_mfma_f32_16x16x32_bf16 v[36:39], v[16:19], v[60:63], v[36:39]
  v_mfma_f32_16x16x32_bf16 v[40:43], v[16:19], v[64:67], v[40:43]
  v_mfma_f32_16x16x32_bf16 v[44:47], v[16:19], v[68:71], v[44:47]
  s_cmp_ge_i32 s76, s99
  s_mov_b32 s76, 32
  s_mov_b32 s77, s46
  s_cbranch_scc1 L_a28
  s_mov_b64 s[76:77], 1
  s_atomic_add_x2 s[76:77], s[44:45], s54 glc
L_a28:
  s_waitcnt vmcnt(6)
  buffer_load_dwordx4 v[120:123], v2, s[8:11], s50 offen offset:0 nt
  s_waitcnt vmcnt(5)
  buffer_load_dwordx4 v[124:127], v2, s[8:11], s50 offen offset:256 nt
  s_waitcnt vmcnt(5)
  buffer_load_dwordx4 v[128:131], v2, s[8:11], s50 offen offset:512 nt
  s_add_u32 s50, s50, 3072
  v_perm_b32 v10, v153, v153, s70
  v_and_b32 v16, v10, v3
  v_and_b32 v17, v10, v4
  v_and_b32 v18, v10, v5
  v_and_b32 v19, v10, v6
  s_nop 1
  v_mfma_f32_16x16x32_bf16 v[36:39], v[16:19], v[72:75], v[36:39]
  v_mfma_f32_16x16x32_bf16 v[40:43], v[16:19], v[76:79], v[40:43]
  v_mfma_f32_16x16x32_bf16 v[44:47], v[16:19], v[80:83], v[44:47]
  s_waitcnt vmcnt(6)
  buffer_load_dwordx4 v[132:135], v2, s[8:11], s50 offen offset:0 nt
  s_waitcnt vmcnt(5)
  buffer_load_dwordx4 v[136:139], v2, s[8:11], s50 offen offset:256 nt
  s_waitcnt vmcnt(5)
  buffer_load_dwordx4 v[140:143], v2, s[8:11], s50 offen offset:512 nt
  s_add_u32 s50, s50, 3072
  v_perm_b32 v10, v153, v153, s71
  v_and_b32 v16, v10, v3
  v_and_b32 v17, v10, v4
  v_and_b32 v18, v10, v5
  v_and_b32 v19, v10, v6
  s_nop 1
  v_mfma_f32_16x16x32_bf16 v[36:39], v[16:19], v[84:87], v[36:39]
  v_mfma_f32_16x16x32_bf16 v[40:43], v[16:19], v[88:91], v[40:43]
  v_mfma_f32_16x16x32_bf16 v[44:47], v[16:19], v[92:95], v[44:47]
L_tk1:
  s_waitcnt lgkmcnt(0)
  s_cmp_lg_u32 s77, s46
  s_cbranch_scc1 L_retry1
  s_cmp_ge_u32 s76, 25
  s_cbranch_scc1 L_db1
  s_lshl_b32 s63, s76, 4
  s_add_u32 s63, s63, s74
  s_mul_i32 s50, s63, 12288
  s_add_u32 s50, s50, s53
  s_and_b32 s64, s63, 31
  s_lshl_b32 s64, s64, 11
  s_lshr_b32 s63, s63, 5
  s_lshl_b32 s63, s63, 6
  s_add_u32 s63, s63, s64
  s_add_u32 s52, s63, s55
  buffer_load_dwordx2 v[152:153], v8, s[12:15], s52 offen sc1
  s_waitcnt vmcnt(6)
  buffer_load_dwordx4 v[48:51], v2, s[8:11], s50 offen offset:0 nt
  s_waitcnt vmcnt(5)
  buffer_load_dwordx4 v[52:55], v2, s[8:11], s50 offen offset:256 nt
  s_waitcnt vmcnt(5)
  buffer_load_dwordx4 v[56:59], v2, s[8:11], s50 offen offset:512 nt
  s_add_u32 s50, s50, 3072
  v_perm_b32 v10, v156, v156, s70
  v_and_b32 v16, v10, v3
  v_and_b32 v17, v10, v4
  v_and_b32 v18, v10, v5
  v_and_b32 v19, v10, v6
  s_nop 1
  v_mfma_f32_16x16x32_bf16 v[36:39], v[16:19], v[96:99], v[36:39]
  v_mfma_f32_16x16x32_bf16 v[40:43], v[16:19], v[100:103], v[40:43]
  v_mfma_f32_16x16x32_bf16 v[44:47], v[16:19], v[104:107], v[44:47]
  s_waitcnt vmcnt(6)
  buffer_load_dwordx4 v[60:63], v2, s[8:11], s50 offen offset:0 nt
  s_waitcnt vmcnt(5)
  buffer_load_dwordx4 v[64:67], v2, s[8:11], s50 offen offset:256 nt
  s_waitcnt vmcnt(5)
  buffer_load_dwordx4 v[68:71], v2, s[8:11], s50 offen offset:512 nt
  s_add_u32 s50, s50, 3072
  v_perm_b32 v10, v156, v156, s71
  v_and_b32 v16, v10, v3
  v_and_b32 v17, v10, v4
  v_and_b32 v18, v10, v5
  v_and_b32 v19, v10, v6
  s_nop 1
  v_mfma_f32_16x16x32_bf16 v[36:39], v[16:19], v[108:111], v[36:39]
  v_mfma_f32_16x16x32_bf16 v[40:43], v[16:19], v[112:115], v[40:43]
  v_mfma_f32_16x16x32_bf16 v[44:47], v[16:19], v[116:119], v[44:47]
  s_cmp_ge_i32 s76, s99
  s_mov_b32 s76, 32
  s_mov_b32 s77, s46
  s_cbranch_scc1 L_a29
  s_mov_b64 s[76:77], 1
  s_atomic_add_x2 s[76:77], s[44:45], s54 glc
L_a29:
  s_waitcnt vmcnt(6)
  buffer_load_dwordx4 v[72:75], v2, s[8:11], s50 offen offset:0 nt
  s_waitcnt vmcnt(5)
  buffer_load_dwordx4 v[76:79], v2, s[8:11], s50 offen offset:256 nt
  s_waitcnt vmcnt(5)
  buffer_load_dwordx4 v[80:83], v2, s[8:11], s50 offen offset:512 nt
  s_add_u32 s50, s50, 3072
  v_perm_b32 v10, v157, v157, s70
  v_and_b32 v16, v10, v3
  v_and_b32 v17, v10, v4
  v_and_b32 v18, v10, v5
  v_and_b32 v19, v10, v6
  s_nop 1
  v_mfma_f32_16x16x32_bf16 v[36:39], v[16:19], v[120:123], v[36:39]
  v_mfma_f32_16x16x32_bf16 v[40:43], v[16:19], v[124:127], v[40:43]
  v_mfma_f32_16x16x32_bf16 v[44:47], v[16:19], v[128:131], v[44:47]
  s_waitcnt vmcnt(6)
  buffer_load_dwordx4 v[84:87], v2, s[8:11], s50 offen offset:0 nt
  s_waitcnt vmcnt(5)
  buffer_load_dwordx4 v[88:91], v2, s[8:11], s50 offen offset:256 nt
  s_waitcnt vmcnt(5)
  buffer_load_dwordx4 v[92:95], v2, s[8:11], s50 offen offset:512 nt
  s_add_u32 s50, s50, 3072
  v_perm_b32 v10, v157, v157, s71
  v_and_b32 v16, v10, v3
  v_and_b32 v17, v10, v4
  v_and_b32 v18, v10, v5
  v_and_b32 v19, v10, v6
  s_nop 1
  v_mfma_f32_16x16x32_bf16 v[36:39], v[16:19], v[132:135], v[36:39]
  v_mfma_f32_16x16x32_bf16 v[40:43], v[16:19], v[136:139], v[40:43]
  v_mfma_f32_16x16x32_bf16 v[44:47], v[16:19], v[140:143], v[44:47]
  s_branch L_d
L_retry0:
  s_sub_u32 s78, s78, 1
  s_cbranch_scc1 L_dx0
  s_mov_b64 s[76:77], 1
  s_atomic_add_x2 s[76:77], s[44:45], s54 glc
  s_branch L_tk0
L_db0:
  s_cmp_ge_u32 s76, 32
  s_cbranch_scc1 L_dx0
  s_lshl_b32 s63, s76, 4
  s_add_u32 s63, s63, s74
  s_mul_i32 s50, s63, 12288
  s_add_u32 s50, s50, s53
  s_and_b32 s64, s63, 31
  s_lshl_b32 s64, s64, 11
  s_lshr_b32 s63, s63, 5
  s_lshl_b32 s63, s63, 6
  s_add_u32 s63, s63, s64
  s_add_u32 s52, s63, s55
  s_cmp_ge_i32 s76, s99
  s_mov_b32 s76, 32
  s_mov_b32 s77, s46
  s_cbranch_scc1 L_a30
  s_mov_b64 s[76:77], 1
  s_atomic_add_x2 s[76:77], s[44:45], s54 glc
L_a30:
  buffer_load_dwordx2 v[156:157], v8, s[12:15], s52 offen sc1
  buffer_load_dwordx4 v[96:99], v2, s[8:11], s50 offen offset:0 nt
  buffer_load_dwordx4 v[100:103], v2, s[8:11], s50 offen offset:256 nt
  buffer_load_dwordx4 v[104:107], v2, s[8:11], s50 offen offset:512 nt
  s_add_u32 s50, s50, 3072
  buffer_load_dwordx4 v[108:111], v2, s[8:11], s50 offen offset:0 nt
  buffer_load_dwordx4 v[112:115], v2, s[8:11], s50 offen offset:256 nt
  buffer_load_dwordx4 v[116:119], v2, s[8:11], s50 offen offset:512 nt
  s_add_u32 s50, s50, 3072
  buffer_load_dwordx4 v[120:123], v2, s[8:11], s50 offen offset:0 nt
  buffer_load_dwordx4 v[124:127], v2, s[8:11], s50 offen offset:256 nt
  buffer_load_dwordx4 v[128:131], v2, s[8:11], s50 offen offset:512 nt
  s_add_u32 s50, s50, 3072
  buffer_load_dwordx4 v[132:135], v2, s[8:11], s50 offen offset:0 nt
  buffer_load_dwordx4 v[136:139], v2, s[8:11], s50 offen offset:256 nt
  buffer_load_dwordx4 v[140:143], v2, s[8:11], s50 offen offset:512 nt
  s_add_u32 s50, s50, 3072
L_dc0:
  s_waitcnt vmcnt(22)
  v_perm_b32 v10, v152, v152, s70
  v_and_b32 v16, v10, v3
  v_and_b32 v17, v10, v4
  v_and_b32 v18, v10, v5
  v_and_b32 v19, v10, v6
  s_nop 1
  v_mfma_f32_16x16x32_bf16 v[36:39], v[16:19], v[48:51], v[36:39]
  v_mfma_f32_16x16x32_bf16 v[40:43], v[16:19], v[52:55], v[40:43]
  v_mfma_f32_16x16x32_bf16 v[44:47], v[16:19], v[56:59], v[44:47]
  s_waitcnt vmcnt(19)
  v_perm_b32 v10, v152, v152, s71
  v_and_b32 v16, v10, v3
  v_and_b32 v17, v10, v4
  v_and_b32 v18, v10, v5
  v_and_b32 v19, v10, v6
  s_nop 1
  v_mfma_f32_16x16x32_bf16 v[36:39], v[16:19], v[60:63], v[36:39]
  v_mfma_f32_16x16x32_bf16 v[40:43], v[16:19], v[64:67], v[40:43]
  v_mfma_f32_16x16x32_bf16 v[44:47], v[16:19], v[68:71], v[44:47]
  s_waitcnt vmcnt(16)
  v_perm_b32 v10, v153, v153, s70
  v_and_b32 v16, v10, v3
  v_and_b32 v17, v10, v4
  v_and_b32 v18, v10, v5
  v_and_b32 v19, v10, v6
  s_nop 1
  v_mfma_f32_16x16x32_bf16 v[36:39], v[16:19], v[72:75], v[36:39]
  v_mfma_f32_16x16x32_bf16 v[40:43], v[16:19], v[76:79], v[40:43]
  v_mfma_f32_16x16x32_bf16 v[44:47], v[16:19], v[80:83], v[44:47]
  s_waitcnt vmcnt(13)
  v_perm_b32 v10, v153, v153, s71
  v_and_b32 v16, v10, v3
  v_and_b32 v17, v10, v4
  v_and_b32 v18, v10, v5
  v_and_b32 v19, v10, v6
  s_nop 1
  v_mfma_f32_16x16x32_bf16 v[36:39], v[16:19], v[84:87], v[36:39]
  v_mfma_f32_16x16x32_bf16 v[40:43], v[16:19], v[88:91], v[40:43]
  v_mfma_f32_16x16x32_bf16 v[44:47], v[16:19], v[92:95], v[44:47]
  s_branch L_tk1
L_dx0:
  s_mov_b64 exec, 1
  ds_add_u32 v147, v148 offset:48
  s_mov_b64 exec, -1
  s_waitcnt vmcnt(9)
  v_perm_b32 v10, v152, v152, s70
  v_and_b32 v16, v10, v3
  v_and_b32 v17, v10, v4
  v_and_b32 v18, v10, v5
  v_and_b32 v19, v10, v6
  s_nop 1
  v_mfma_f32_16x16x32_bf16 v[36:39], v[16:19], v[48:51], v[36:39]
  v_mfma_f32_16x16x32_bf16 v[40:43], v[16:19], v[52:55], v[40:43]
  v_mfma_f32_16x16x32_bf16 v[44:47], v[16:19], v[56:59], v[44:47]
  s_waitcnt vmcnt(6)
  v_perm_b32 v10, v152, v152, s71
  v_and_b32 v16, v10, v3
  v_and_b32 v17, v10, v4
  v_and_b32 v18, v10, v5
  v_and_b32 v19, v10, v6
  s_nop 1
  v_mfma_f32_16x16x32_bf16 v[36:39], v[16:19], v[60:63], v[36:39]
  v_mfma_f32_16x16x32_bf16 v[40:43], v[16:19], v[64:67], v[40:43]
  v_mfma_f32_16x16x32_bf16 v[44:47], v[16:19], v[68:71], v[44:47]
  s_waitcnt vmcnt(3)
  v_perm_b32 v10, v153, v153, s70
  v_and_b32 v16, v10, v3
  v_and_b32 v17, v10, v4
  v_and_b32 v18, v10, v5
  v_and_b32 v19, v10, v6
  s_nop 1
  v_mfma_f32_16x16x32_bf16 v[36:39], v[16:19], v[72:75], v[36:39]
  v_mfma_f32_16x16x32_bf16 v[40:43], v[16:19], v[76:79], v[40:43]
  v_mfma_f32_16x16x32_bf16 v[44:47], v[16:19], v[80:83], v[44:47]
  s_waitcnt vmcnt(0)
  v_perm_b32 v10, v153, v153, s71
  v_and_b32 v16, v10, v3
  v_and_b32 v17, v10, v4
  v_and_b32 v18, v10, v5
  v_and_b32 v19, v10, v6
  s_nop 1
  v_mfma_f32_16x16x32_bf16 v[36:39], v[16:19], v[84:87], v[36:39]
  v_mfma_f32_16x16x32_bf16 v[40:43], v[16:19], v[88:91], v[40:43]
  v_mfma_f32_16x16x32_bf16 v[44:47], v[16:19], v[92:95], v[44:47]
  s_branch L_dx
L_retry1:
  s_sub_u32 s78, s78, 1
  s_cbranch_scc1 L_dx1
  s_mov_b64 s[76:77], 1
  s_atomic_add_x2 s[76:77], s[44:45], s54 glc
  s_branch L_tk1
L_db1:
  s_cmp_ge_u32 s76, 32
  s_cbranch_scc1 L_dx1
  s_lshl_b32 s63, s76, 4
  s_add_u32 s63, s63, s74
  s_mul_i32 s50, s63, 12288
  s_add_u32 s50, s50, s53
  s_and_b32 s64, s63, 31
  s_lshl_b32 s64, s64, 11
  s_lshr_b32 s63, s63, 5
  s_lshl_b32 s63, s63, 6
  s_add_u32 s63, s63, s64
  s_add_u32 s52, s63, s55
  s_cmp_ge_i32 s76, s99
  s_mov_b32 s76, 32
  s_mov_b32 s77, s46
  s_cbranch_scc1 L_a31
  s_mov_b64 s[76:77], 1
  s_atomic_add_x2 s[76:77], s[44:45], s54 glc
L_a31:
  buffer_load_dwordx2 v[152:153], v8, s[12:15], s52 offen sc1
  buffer_load_dwordx4 v[48:51], v2, s[8:11], s50 offen offset:0 nt
  buffer_load_dwordx4 v[52:55], v2, s[8:11], s50 offen offset:256 nt
  buffer_load_dwordx4 v[56:59], v2, s[8:11], s50 offen offset:512 nt
  s_add_u32 s50, s50, 3072
  buffer_load_dwordx4 v[60:63], v2, s[8:11], s50 offen offset:0 nt
  buffer_load_dwordx4 v[64:67], v2, s[8:11], s50 offen offset:256 nt
  buffer_load_dwordx4 v[68:71], v2, s[8:11], s50 offen offset:512 nt
  s_add_u32 s50, s50, 3072
  buffer_load_dwordx4 v[72:75], v2, s[8:11], s50 offen offset:0 nt
  buffer_load_dwordx4 v[76:79], v2, s[8:11], s50 offen offset:256 nt
  buffer_load_dwordx4 v[80:83], v2, s[8:11], s50 offen offset:512 nt
  s_add_u32 s50, s50, 3072
  buffer_load_dwordx4 v[84:87], v2, s[8:11], s50 offen offset:0 nt
  buffer_load_dwordx4 v[88:91], v2, s[8:11], s50 offen offset:256 nt
  buffer_load_dwordx4 v[92:95], v2, s[8:11], s50 offen offset:512 nt
  s_add_u32 s50, s50, 3072
L_dc1:
  s_waitcnt vmcnt(22)
  v_perm_b32 v10, v156, v156, s70
  v_and_b32 v16, v10, v3
  v_and_b32 v17, v10, v4
  v_and_b32 v18, v10, v5
  v_and_b32 v19, v10, v6
  s_nop 1
  v_mfma_f32_16x16x32_bf16 v[36:39], v[16:19], v[96:99], v[36:39]
  v_mfma_f32_16x16x32_bf16 v[40:43], v[16:19], v[100:103], v[40:43]
  v_mfma_f32_16x16x32_bf16 v[44:47], v[16:19], v[104:107], v[44:47]
  s_waitcnt vmcnt(19)
  v_perm_b32 v10, v156, v156, s71
  v_and_b32 v16, v10, v3
  v_and_b32 v17, v10, v4
  v_and_b32 v18, v10, v5
  v_and_b32 v19, v10, v6
  s_nop 1
  v_mfma_f32_16x16x32_bf16 v[36:39], v[16:19], v[108:111], v[36:39]
  v_mfma_f32_16x16x32_bf16 v[40:43], v[16:19], v[112:115], v[40:43]
  v_mfma_f32_16x16x32_bf16 v[44:47], v[16:19], v[116:119], v[44:47]
  s_waitcnt vmcnt(16)
  v_perm_b32 v10, v157, v157, s70
  v_and_b32 v16, v10, v3
  v_and_b32 v17, v10, v4
  v_and_b32 v18, v10, v5
  v_and_b32 v19, v10, v6
  s_nop 1
  v_mfma_f32_16x16x32_bf16 v[36:39], v[16:19], v[120:123], v[36:39]
  v_mfma_f32_16x16x32_bf16 v[40:43], v[16:19], v[124:127], v[40:43]
  v_mfma_f32_16x16x32_bf16 v[44:47], v[16:19], v[128:131], v[44:47]
  s_waitcnt vmcnt(13)
  v_perm_b32 v10, v157, v157, s71
  v_and_b32 v16, v10, v3
  v_and_b32 v17, v10, v4
  v_and_b32 v18, v10, v5
  v_and_b32 v19, v10, v6
  s_nop 1
  v_mfma_f32_16x16x32_bf16 v[36:39], v[16:19], v[132:135], v[36:39]
  v_mfma_f32_16x16x32_bf16 v[40:43], v[16:19], v[136:139], v[40:43]
  v_mfma_f32_16x16x32_bf16 v[44:47], v[16:19], v[140:143], v[44:47]
  s_branch L_tk0
L_dx1:
  s_mov_b64 exec, 1
  ds_add_u32 v147, v148 offset:48
  s_mov_b64 exec, -1
  s_waitcnt vmcnt(9)
  v_perm_b32 v10, v156, v156, s70
  v_and_b32 v16, v10, v3
  v_and_b32 v17, v10, v4
  v_and_b32 v18, v10, v5
  v_and_b32 v19, v10, v6
  s_nop 1
  v_mfma_f32_16x16x32_bf16 v[36:39], v[16:19], v[96:99], v[36:39]
  v_mfma_f32_16x16x32_bf16 v[40:43], v[16:19], v[100:103], v[40:43]
  v_mfma_f32_16x16x32_bf16 v[44:47], v[16:19], v[104:107], v[44:47]
  s_waitcnt vmcnt(6)
  v_perm_b32 v10, v156, v156, s71
  v_and_b32 v16, v10, v3
  v_and_b32 v17, v10, v4
  v_and_b32 v18, v10, v5
  v_and_b32 v19, v10, v6
  s_nop 1
  v_mfma_f32_16x16x32_bf16 v[36:39], v[16:19], v[108:111], v[36:39]
  v_mfma_f32_16x16x32_bf16 v[40:43], v[16:19], v[112:115], v[40:43]
  v_mfma_f32_16x16x32_bf16 v[44:47], v[16:19], v[116:119], v[44:47]
  s_waitcnt vmcnt(3)
  v_perm_b32 v10, v157, v157, s70
  v_and_b32 v16, v10, v3
  v_and_b32 v17, v10, v4
  v_and_b32 v18, v10, v5
  v_and_b32 v19, v10, v6
  s_nop 1
  v_mfma_f32_16x16x32_bf16 v[36:39], v[16:19], v[120:123], v[36:39]
  v_mfma_f32_16x16x32_bf16 v[40:43], v[16:19], v[124:127], v[40:43]
  v_mfma_f32_16x16x32_bf16 v[44:47], v[16:19], v[128:131], v[44:47]
  s_waitcnt vmcnt(0)
  v_perm_b32 v10, v157, v157, s71
  v_and_b32 v16, v10, v3
  v_and_b32 v17, v10, v4
  v_and_b32 v18, v10, v5
  v_and_b32 v19, v10, v6
  s_nop 1
  v_mfma_f32_16x16x32_bf16 v[36:39], v[16:19], v[132:135], v[36:39]
  v_mfma_f32_16x16x32_bf16 v[40:43], v[16:19], v[136:139], v[40:43]
  v_mfma_f32_16x16x32_bf16 v[44:47], v[16:19], v[140:143], v[44:47]
  s_branch L_dx
L_slowv0:
  s_mov_b32 s78, 1000000
L_f32:
  ds_read_b32 v9, v150 offset:16
  s_sub_u32 s78, s78, 1
  s_cbranch_scc1 L_f32_x
  s_waitcnt lgkmcnt(0)
  v_readfirstlane_b32 s63, v9
  s_nop 0
  s_cmp_ge_u32 s63, 1
  s_cbranch_scc1 L_f32_x
  s_sleep 1
  s_branch L_f32
L_f32_x:
  s_waitcnt lgkmcnt(0)
  ds_read_b32 v24, v7 offset:0
  ds_read_b32 v25, v7 offset:128
  ds_read_b32 v26, v7 offset:256
  ds_read_b32 v27, v7 offset:384
  ds_read_b32 v28, v7 offset:512
  ds_read_b32 v29, v7 offset:640
  ds_read_b32 v30, v7 offset:768
  ds_read_b32 v31, v7 offset:896
  s_waitcnt lgkmcnt(0)
  s_mov_b32 s78, 1000000
  s_branch L_backv0
L_slowd:
  s_mov_b32 s78, 1000000
L_f33:
  ds_read_b32 v9, v150 offset:16
  s_sub_u32 s78, s78, 1
  s_cbranch_scc1 L_f33_x
  s_waitcnt lgkmcnt(0)
  v_readfirstlane_b32 s63, v9
  s_nop 0
  s_cmp_ge_u32 s63, 1
  s_cbranch_scc1 L_f33_x
  s_sleep 1
  s_branch L_f33
L_f33_x:
  s_waitcnt lgkmcnt(0)
  s_mov_b32 s78, 1000000
L_f34:
  ds_read_b32 v9, v147 offset:56
  s_sub_u32 s78, s78, 1
  s_cbranch_scc1 L_f34_x
  s_waitcnt lgkmcnt(0)
  v_readfirstlane_b32 s63, v9
  s_nop 0
  s_cmp_ge_u32 s63, 1
  s_cbranch_scc1 L_f34_x
  s_sleep 1
  s_branch L_f34
L_f34_x:
  s_waitcnt lgkmcnt(0)
  s_mov_b32 s78, 1000000
L_f35:
  ds_read_b32 v9, v147 offset:72
  s_sub_u32 s78, s78, 1
  s_cbranch_scc1 L_f35_x
  s_waitcnt lgkmcnt(0)
  v_readfirstlane_b32 s63, v9
  s_nop 0
  s_cmp_ge_u32 s63, 1
  s_cbranch_scc1 L_f35_x
  s_sleep 1
  s_branch L_f35
L_f35_x:
  s_waitcnt lgkmcnt(0)
  v_mov_b32 v21, v9
  ds_read_b32 v24, v7 offset:0
  ds_read_b32 v25, v7 offset:128
  ds_read_b32 v26, v7 offset:256
  ds_read_b32 v27, v7 offset:384
  ds_read_b32 v28, v7 offset:512
  ds_read_b32 v29, v7 offset:640
  ds_read_b32 v30, v7 offset:768
  ds_read_b32 v31, v7 offset:896
  s_waitcnt lgkmcnt(0)
  s_mov_b32 s78, 1000000
  s_branch L_backd
L_dx:
L_done:
  s_nop 4
  ds_write_b128 v144, v[36:39]
  ds_write_b128 v145, v[40:43]
  ds_write_b128 v146, v[44:47]
  s_waitcnt lgkmcnt(0)
  s_barrier
  s_barrier
  ds_read_b32 v9, v147 offset:52
  s_waitcnt lgkmcnt(0)
  v_readfirstlane_b32 s49, v9
  s_nop 0
  s_cmp_lt_u32 s49, 80
  s_cbranch_scc1 L_W
  s_sub_u32 s63, s49, 128
  s_cmp_lt_u32 s63, 80
  s_cbranch_scc1 L_E
L_notW:
  s_cmp_ge_u32 s49, 108
  s_cbranch_scc1 L_fin
  s_cmp_ge_u32 s49, 104
  s_cbranch_scc1 L_R
  v_lshrrev_b32 v10, 3, v0
  v_mul_u32_u24 v10, 3072, v10
  v_and_b32 v11, 7, v0
  v_lshl_add_u32 v20, v11, 4, v10
  s_sub_u32 s72, s49, 80
  s_lshl_b32 s63, s72, 7
  s_mul_i32 s64, s3, 393216
  s_add_u32 s63, s63, s64
  s_lshl_b32 s73, s3, 14
  s_add_u32 s73, s73, 61440
  s_mov_b32 m0, s73
  s_mov_b32 s16, s36
  s_and_b32 s17, s37, 0xffff
  s_mov_b32 s18, 1966080
  s_mov_b32 s19, 0x20000
  buffer_load_dwordx4 v20, s[16:19], s63 offen nt lds
  s_add_u32 m0, m0, 1024
  s_add_u32 s63, s63, 24576
  buffer_load_dwordx4 v20, s[16:19], s63 offen nt lds
  s_add_u32 m0, m0, 1024
  s_add_u32 s63, s63, 24576
  buffer_load_dwordx4 v20, s[16:19], s63 offen nt lds
  s_add_u32 m0, m0, 1024
  s_add_u32 s63, s63, 24576
  buffer_load_dwordx4 v20, s[16:19], s63 offen nt lds
  s_add_u32 m0, m0, 1024
  s_add_u32 s63, s63, 24576
  buffer_load_dwordx4 v20, s[16:19], s63 offen nt lds
  s_add_u32 m0, m0, 1024
  s_add_u32 s63, s63, 24576
  buffer_load_dwordx4 v20, s[16:19], s63 offen nt lds
  s_add_u32 m0, m0, 1024
  s_add_u32 s63, s63, 24576
  buffer_load_dwordx4 v20, s[16:19], s63 offen nt lds
  s_add_u32 m0, m0, 1024
  s_add_u32 s63, s63, 24576
  buffer_load_dwordx4 v20, s[16:19], s63 offen nt lds
  s_add_u32 m0, m0, 1024
  s_add_u32 s63, s63, 24576
  buffer_load_dwordx4 v20, s[16:19], s63 offen nt lds
  s_add_u32 m0, m0, 1024
  s_add_u32 s63, s63, 24576
  buffer_load_dwordx4 v20, s[16:19], s63 offen nt lds
  s_add_u32 m0, m0, 1024
  s_add_u32 s63, s63, 24576
  buffer_load_dwordx4 v20, s[16:19], s63 offen nt lds
  s_add_u32 m0, m0, 1024
  s_add_u32 s63, s63, 24576
  buffer_load_dwordx4 v20, s[16:19], s63 offen nt lds
  s_add_u32 m0, m0, 1024
  s_add_u32 s63, s63, 24576
  buffer_load_dwordx4 v20, s[16:19], s63 offen nt lds
  s_add_u32 m0, m0, 1024
  s_add_u32 s63, s63, 24576
  buffer_load_dwordx4 v20, s[16:19], s63 offen nt lds
  s_add_u32 m0, m0, 1024
  s_add_u32 s63, s63, 24576
  buffer_load_dwordx4 v20, s[16:19], s63 offen nt lds
  s_add_u32 m0, m0, 1024
  s_add_u32 s63, s63, 24576
  buffer_load_dwordx4 v20, s[16:19], s63 offen nt lds
  v_lshrrev_b32 v10, 4, v0
  v_bfe_u32 v11, v0, 2, 2
  v_lshl_add_u32 v21, v10, 3, v11
  v_and_b32 v11, 3, v0
  v_lshlrev_b32 v11, 3, v11
  s_lshl_b32 s63, s3, 5
  s_add_u32 s63, s63, 61440
  v_lshl_add_u32 v22, v21, 7, v11
  v_add_u32 v22, s63, v22
  v_add_u32 v23, 40960, v22
  s_mul_i32 s63, s3, 320
  s_add_u32 s63, s63, 61440
  v_mul_u32_u24 v21, 1280, v21
  v_add3_u32 v21, v21, v11, s63
  s_mov_b32 s20, s38
  s_and_b32 s21, s39, 0xffff
  s_mov_b32 s22, 1966080
  s_mov_b32 s23, 0x20000
  s_mul_i32 s63, s72, 81920
  s_lshl_b32 s64, s3, 14
  s_add_u32 s63, s63, s64
  v_lshlrev_b32 v20, 4, v0
  buffer_load_dwordx4 v[48:51], v20, s[20:23], s63 offen offset:0 nt
  buffer_load_dwordx4 v[52:55], v20, s[20:23], s63 offen offset:1024 nt
  buffer_load_dwordx4 v[56:59], v20, s[20:23], s63 offen offset:2048 nt
  buffer_load_dwordx4 v[60:63], v20, s[20:23], s63 offen offset:3072 nt
  s_add_u32 s63, s63, 4096
  buffer_load_dwordx4 v[64:67], v20, s[20:23], s63 offen offset:0 nt
  buffer_load_dwordx4 v[68:71], v20, s[20:23], s63 offen offset:1024 nt
  buffer_load_dwordx4 v[72:75], v20, s[20:23], s63 offen offset:2048 nt
  buffer_load_dwordx4 v[76:79], v20, s[20:23], s63 offen offset:3072 nt
  s_add_u32 s63, s63, 4096
  buffer_load_dwordx4 v[80:83], v20, s[20:23], s63 offen offset:0 nt
  buffer_load_dwordx4 v[84:87], v20, s[20:23], s63 offen offset:1024 nt
  buffer_load_dwordx4 v[88:91], v20, s[20:23], s63 offen offset:2048 nt
  buffer_load_dwordx4 v[92:95], v20, s[20:23], s63 offen offset:3072 nt
  s_add_u32 s63, s63, 4096
  buffer_load_dwordx4 v[96:99], v20, s[20:23], s63 offen offset:0 nt
  buffer_load_dwordx4 v[100:103], v20, s[20:23], s63 offen offset:1024 nt
  buffer_load_dwordx4 v[104:107], v20, s[20:23], s63 offen offset:2048 nt
  buffer_load_dwordx4 v[108:111], v20, s[20:23], s63 offen offset:3072 nt
  v_add_u32 v20, s73, v20
  s_waitcnt vmcnt(16)
  s_barrier
  s_cmp_eq_u32 s3, 4
  s_cbranch_scc1 L_F_t1
  ds_read_b64_tr_b16 a[0:1], v22 offset:0
  ds_read_b64_tr_b16 a[2:3], v22 offset:512
  ds_read_b64_tr_b16 a[4:5], v22 offset:4096
  ds_read_b64_tr_b16 a[6:7], v22 offset:4608
  ds_read_b64_tr_b16 a[8:9], v22 offset:8192
  ds_read_b64_tr_b16 a[10:11], v22 offset:8704
  ds_read_b64_tr_b16 a[12:13], v22 offset:12288
  ds_read_b64_tr_b16 a[14:15], v22 offset:12800
  s_waitcnt lgkmcnt(0)
  ds_read_b64_tr_b16 a[16:17], v22 offset:16384
  ds_read_b64_tr_b16 a[18:19], v22 offset:16896
  ds_read_b64_tr_b16 a[20:21], v22 offset:20480
  ds_read_b64_tr_b16 a[22:23], v22 offset:20992
  ds_read_b64_tr_b16 a[24:25], v22 offset:24576
  ds_read_b64_tr_b16 a[26:27], v22 offset:25088
  ds_read_b64_tr_b16 a[28:29], v22 offset:28672
  ds_read_b64_tr_b16 a[30:31], v22 offset:29184
  s_waitcnt lgkmcnt(0)
  ds_read_b64_tr_b16 a[32:33], v22 offset:32768
  ds_read_b64_tr_b16 a[34:35], v22 offset:33280
  ds_read_b64_tr_b16 a[36:37], v22 offset:36864
  ds_read_b64_tr_b16 a[38:39], v22 offset:37376
  ds_read_b64_tr_b16 a[40:41], v23 offset:0
  ds_read_b64_tr_b16 a[42:43], v23 offset:512
  ds_read_b64_tr_b16 a[44:45], v23 offset:4096
  ds_read_b64_tr_b16 a[46:47], v23 offset:4608
  s_waitcnt lgkmcnt(0)
  ds_read_b64_tr_b16 a[48:49], v23 offset:8192
  ds_read_b64_tr_b16 a[50:51], v23 offset:8704
  ds_read_b64_tr_b16 a[52:53], v23 offset:12288
  ds_read_b64_tr_b16 a[54:55], v23 offset:12800
  ds_read_b64_tr_b16 a[56:57], v23 offset:16384
  ds_read_b64_tr_b16 a[58:59], v23 offset:16896
  ds_read_b64_tr_b16 a[60:61], v23 offset:20480
  ds_read_b64_tr_b16 a[62:63], v23 offset:20992
  s_waitcnt lgkmcnt(0)
  ds_read_b64_tr_b16 a[64:65], v23 offset:24576
  ds_read_b64_tr_b16 a[66:67], v23 offset:25088
  ds_read_b64_tr_b16 a[68:69], v23 offset:28672
  ds_read_b64_tr_b16 a[70:71], v23 offset:29184
  ds_read_b64_tr_b16 a[72:73], v23 offset:32768
  ds_read_b64_tr_b16 a[74:75], v23 offset:33280
  ds_read_b64_tr_b16 a[76:77], v23 offset:36864
  ds_read_b64_tr_b16 a[78:79], v23 offset:37376
  s_waitcnt lgkmcnt(0)
L_F_t1:
  s_barrier
  s_mov_b32 m0, s73
  s_waitcnt vmcnt(15)
  ds_write_b128 v20, v[48:51] offset:0
  s_waitcnt vmcnt(14)
  ds_write_b128 v20, v[52:55] offset:1024
  s_waitcnt vmcnt(13)
  ds_write_b128 v20, v[56:59] offset:2048
  s_waitcnt vmcnt(12)
  ds_write_b128 v20, v[60:63] offset:3072
  s_waitcnt vmcnt(11)
  ds_write_b128 v20, v[64:67] offset:4096
  s_waitcnt vmcnt(10)
  ds_write_b128 v20, v[68:71] offset:5120
  s_waitcnt vmcnt(9)
  ds_write_b128 v20, v[72:75] offset:6144
  s_waitcnt vmcnt(8)
  ds_write_b128 v20, v[76:79] offset:7168
  s_waitcnt vmcnt(7)
  ds_write_b128 v20, v[80:83] offset:8192
  s_waitcnt vmcnt(6)
  ds_write_b128 v20, v[84:87] offset:9216
  s_waitcnt vmcnt(5)
  ds_write_b128 v20, v[88:91] offset:10240
  s_waitcnt vmcnt(4)
  ds_write_b128 v20, v[92:95] offset:11264
  s_waitcnt vmcnt(3)
  ds_write_b128 v20, v[96:99] offset:12288
  s_waitcnt vmcnt(2)
  ds_write_b128 v20, v[100:103] offset:13312
  s_waitcnt vmcnt(1)
  ds_write_b128 v20, v[104:107] offset:14336
  s_waitcnt vmcnt(0)
  ds_write_b128 v20, v[108:111] offset:15360
  s_waitcnt vmcnt(0) lgkmcnt(0)
  s_barrier
  s_cmp_eq_u32 s3, 4
  s_cbranch_scc1 L_F
  ds_read_b64_tr_b16 a[80:81], v21 offset:0
  ds_read_b64_tr_b16 a[82:83], v21 offset:5120
  ds_read_b64_tr_b16 a[84:85], v21 offset:40960
  ds_read_b64_tr_b16 a[86:87], v21 offset:46080
  ds_read_b64_tr_b16 a[88:89], v21 offset:32
  ds_read_b64_tr_b16 a[90:91], v21 offset:5152
  ds_read_b64_tr_b16 a[92:93], v21 offset:40992
  ds_read_b64_tr_b16 a[94:95], v21 offset:46112
  s_waitcnt lgkmcnt(0)
  ds_read_b64_tr_b16 v[48:49], v21 offset:64
  ds_read_b64_tr_b16 v[50:51], v21 offset:5184
  ds_read_b64_tr_b16 v[52:53], v21 offset:41024
  ds_read_b64_tr_b16 v[54:55], v21 offset:46144
  ds_read_b64_tr_b16 v[56:57], v21 offset:96
  ds_read_b64_tr_b16 v[58:59], v21 offset:5216
  ds_read_b64_tr_b16 v[60:61], v21 offset:41056
  ds_read_b64_tr_b16 v[62:63], v21 offset:46176
  s_waitcnt lgkmcnt(0)
  ds_read_b64_tr_b16 v[64:65], v21 offset:128
  ds_read_b64_tr_b16 v[66:67], v21 offset:5248
  ds_read_b64_tr_b16 v[68:69], v21 offset:41088
  ds_read_b64_tr_b16 v[70:71], v21 offset:46208
  ds_read_b64_tr_b16 v[72:73], v21 offset:160
  ds_read_b64_tr_b16 v[74:75], v21 offset:5280
  ds_read_b64_tr_b16 v[76:77], v21 offset:41120
  ds_read_b64_tr_b16 v[78:79], v21 offset:46240
  s_waitcnt lgkmcnt(0)
  ds_read_b64_tr_b16 v[80:81], v21 offset:192
  ds_read_b64_tr_b16 v[82:83], v21 offset:5312
  ds_read_b64_tr_b16 v[84:85], v21 offset:41152
  ds_read_b64_tr_b16 v[86:87], v21 offset:46272
  ds_read_b64_tr_b16 v[88:89], v21 offset:224
  ds_read_b64_tr_b16 v[90:91], v21 offset:5344
  ds_read_b64_tr_b16 v[92:93], v21 offset:41184
  ds_read_b64_tr_b16 v[94:95], v21 offset:46304
  s_waitcnt lgkmcnt(0)
  ds_read_b64_tr_b16 v[96:97], v21 offset:256
  ds_read_b64_tr_b16 v[98:99], v21 offset:5376
  ds_read_b64_tr_b16 v[100:101], v21 offset:41216
  ds_read_b64_tr_b16 v[102:103], v21 offset:46336
  ds_read_b64_tr_b16 v[104:105], v21 offset:288
  ds_read_b64_tr_b16 v[106:107], v21 offset:5408
  ds_read_b64_tr_b16 v[108:109], v21 offset:41248
  ds_read_b64_tr_b16 v[110:111], v21 offset:46368
  s_waitcnt lgkmcnt(0)
L_F:
  s_mov_b32 s8, s24
  s_and_b32 s9, s25, 0xffff
  s_mov_b32 s10, 1280
  s_mov_b32 s11, 0x20000
  s_lshl_b32 s63, s3, 6
  v_add_u32 v1, s63, v0
  v_lshlrev_b32 v2, 2, v1
  v_lshlrev_b32 v1, 4, v1
  buffer_load_dword v147, v2, s[8:11], 0 offen
  s_mov_b32 s64, 540672
  s_mov_b32 s65, 545792
  s_mov_b32 s66, 550912
  s_mov_b32 s67, 556032
  s_mov_b32 s68, 561152
  s_mov_b32 s69, 566272
  s_mov_b32 s70, 571392
  s_mov_b32 s71, 576512
  v_add_u32 v149, 52288, v2
  v_lshrrev_b32 v150, 4, v0
  v_lshlrev_b32 v150, 4, v150
  v_and_b32 v10, 15, v0
  s_lshl_b32 s63, s3, 5
  s_add_u32 s63, s63, 57600
  v_lshlrev_b32 v152, 1, v10
  v_add_u32 v152, s63, v152
  s_lshl_b32 s63, s3, 3
  s_add_u32 s63, s63, 52224
  v_mov_b32 v154, s63
  v_mov_b32 v155, 0
  v_lshlrev_b32 v156, 4, v0
  s_sub_u32 s72, s49, 80
  s_mul_i32 s72, s72, 5120
  s_mul_i32 s63, s3, 1280
  s_add_u32 s72, s72, s63
  s_add_u32 s72, s72, 409600
  s_mov_b32 s56, 0xffff0000
  s_mov_b32 s57, 0xffff0000
  s_mov_b32 s58, 0
  s_mov_b32 s59, -1
  s_mov_b32 s78, 1000000
L_p36:
  buffer_load_dwordx4 v[112:115], v1, s[12:15], s64 offen sc1
  buffer_load_dwordx4 v[116:119], v1, s[12:15], s65 offen sc1
  buffer_load_dwordx4 v[120:123], v1, s[12:15], s66 offen sc1
  buffer_load_dwordx4 v[124:127], v1, s[12:15], s67 offen sc1
  buffer_load_dwordx4 v[128:131], v1, s[12:15], s68 offen sc1
  buffer_load_dwordx4 v[132:135], v1, s[12:15], s69 offen sc1
  buffer_load_dwordx4 v[136:139], v1, s[12:15], s70 offen sc1
  buffer_load_dwordx4 v[140:143], v1, s[12:15], s71 offen sc1
  s_sub_u32 s78, s78, 1
  s_cbranch_scc1 L_p36_x
  s_waitcnt vmcnt(0)
  v_min_u32 v10, v114, v142
  v_max_u32 v11, v114, v142
  v_min3_u32 v10, v10, v118, v122
  v_max3_u32 v11, v11, v118, v122
  v_min3_u32 v10, v10, v126, v130
  v_max3_u32 v11, v11, v126, v130
  v_min3_u32 v10, v10, v134, v138
  v_max3_u32 v11, v11, v134, v138
  v_cmp_ne_u32 vcc, s46, v10
  v_cmp_ne_u32 s[80:81], s46, v11
  s_nop 0
  s_or_b64 vcc, vcc, s[80:81]
  s_cbranch_vccz L_p36_x
  s_sleep 8
  s_branch L_p36
L_p36_x:
  s_waitcnt vmcnt(0)
  v_add_f32 v42, v112, v116
  v_add_f32 v43, v113, v117
  v_add_f32 v42, v42, v120
  v_add_f32 v43, v43, v121
  v_add_f32 v42, v42, v124
  v_add_f32 v43, v43, v125
  v_add_f32 v42, v42, v128
  v_add_f32 v43, v43, v129
  v_add_f32 v42, v42, v132
  v_add_f32 v43, v43, v133
  v_add_f32 v42, v42, v136
  v_add_f32 v43, v43, v137
  v_add_f32 v42, v42, v140
  v_add_f32 v43, v43, v141
  s_mov_b32 s64, 360448
  s_mov_b32 s65, 365568
  s_mov_b32 s66, 370688
  s_mov_b32 s67, 375808
  s_mov_b32 s68, 380928
  s_mov_b32 s69, 386048
  s_mov_b32 s70, 391168
  s_mov_b32 s71, 396288
  v_lshlrev_b32 v20, 16, v147
  v_and_b32 v21, s62, v147
  s_mov_b32 s78, 1000000
L_p37:
  buffer_load_dwordx4 v[112:115], v1, s[12:15], s64 offen sc1
  buffer_load_dwordx4 v[116:119], v1, s[12:15], s65 offen sc1
  buffer_load_dwordx4 v[120:123], v1, s[12:15], s66 offen sc1
  buffer_load_dwordx4 v[124:127], v1, s[12:15], s67 offen sc1
  buffer_load_dwordx4 v[128:131], v1, s[12:15], s68 offen sc1
  buffer_load_dwordx4 v[132:135], v1, s[12:15], s69 offen sc1
  buffer_load_dwordx4 v[136:139], v1, s[12:15], s70 offen sc1
  buffer_load_dwordx4 v[140:143], v1, s[12:15], s71 offen sc1
  s_sub_u32 s78, s78, 1
  s_cbranch_scc1 L_p37_x
  s_waitcnt vmcnt(0)
  v_min_u32 v10, v114, v142
  v_max_u32 v11, v114, v142
  v_min3_u32 v10, v10, v118, v122
  v_max3_u32 v11, v11, v118, v122
  v_min3_u32 v10, v10, v126, v130
  v_max3_u32 v11, v11, v126, v130
  v_min3_u32 v10, v10, v134, v138
  v_max3_u32 v11, v11, v134, v138
  v_cmp_ne_u32 vcc, s46, v10
  v_cmp_ne_u32 s[80:81], s46, v11
  s_nop 0
  s_or_b64 vcc, vcc, s[80:81]
  s_cbranch_vccnz L_p37
L_p37_x:
  s_waitcnt vmcnt(0)
  v_pk_add_f32 v[112:113], v[112:113], v[116:117]
  v_pk_add_f32 v[120:121], v[120:121], v[124:125]
  v_pk_add_f32 v[128:129], v[128:129], v[132:133]
  v_pk_add_f32 v[136:137], v[136:137], v[140:141]
  v_pk_add_f32 v[112:113], v[112:113], v[120:121]
  v_pk_add_f32 v[128:129], v[128:129], v[136:137]
  v_pk_add_f32 v[42:43], v[42:43], v[112:113]
  v_pk_add_f32 v[10:11], v[42:43], v[128:129]
  v_cvt_pk_bf16_f32 v10, v10, v11
  v_and_b32 v11, s62, v10
  v_lshlrev_b32 v10, 16, v10
  v_add_f32 v10, v10, v20
  v_add_f32 v11, v11, v21
  v_cvt_pk_bf16_f32 v144, v10, v11
  v_mov_b32 v146, s46
  v_lshlrev_b32 v22, 16, v144
  v_and_b32 v23, s62, v144
  s_cmp_lg_u32 s49, 80
  s_cbranch_scc1 L_F_nohp
  s_mov_b32 s63, 401408
  buffer_store_dwordx4 v[144:147], v1, s[12:15], s63 offen sc1
L_F_nohp:
  v_add_f32 v40, v22, v23
  v_mul_f32 v41, v22, v22
  v_fmac_f32 v41, v23, v23
  v_add_f32_dpp v40, v40, v40 quad_perm:[1,0,3,2] row_mask:0xf bank_mask:0xf
  s_nop 0
  v_add_f32_dpp v41, v41, v41 quad_perm:[1,0,3,2] row_mask:0xf bank_mask:0xf
  v_add_f32_dpp v40, v40, v40 quad_perm:[2,3,0,1] row_mask:0xf bank_mask:0xf
  s_nop 0
  v_add_f32_dpp v41, v41, v41 quad_perm:[2,3,0,1] row_mask:0xf bank_mask:0xf
  v_add_f32_dpp v40, v40, v40 row_half_mirror row_mask:0xf bank_mask:0xf
  s_nop 0
  v_add_f32_dpp v41, v41, v41 row_half_mirror row_mask:0xf bank_mask:0xf
  v_add_f32_dpp v40, v40, v40 row_mirror row_mask:0xf bank_mask:0xf
  s_nop 0
  v_add_f32_dpp v41, v41, v41 row_mirror row_mask:0xf bank_mask:0xf
  v_mov_b32 v10, v40
  v_mov_b32 v11, v41
  s_nop 0
  v_permlane16_swap_b32 v40, v10
  v_permlane16_swap_b32 v41, v11
  v_add_f32 v40, v40, v10
  v_add_f32 v41, v41, v11
  v_mov_b32 v10, v40
  v_mov_b32 v11, v41
  s_nop 0
  v_permlane32_swap_b32 v40, v10
  v_permlane32_swap_b32 v41, v11
  v_add_f32 v40, v40, v10
  v_add_f32 v41, v41, v11
  ds_write_b64 v154, v[40:41]
  s_waitcnt lgkmcnt(0)
  s_barrier
  ds_read_b128 v[24:27], v155 offset:52224
  ds_read_b128 v[28:31], v155 offset:52240
  ds_read_b64 v[32:33], v155 offset:52256
  s_waitcnt lgkmcnt(0)
  v_add_f32 v10, v24, v26
  v_add_f32 v20, v25, v27
  v_add_f32 v11, v28, v30
  v_add_f32 v21, v29, v31
  v_add_f32 v10, v10, v32
  v_add_f32 v20, v20, v33
  v_add_f32 v10, v10, v11
  v_add_f32 v20, v20, v21
  v_mul_f32 v10, 0x3acccccd, v10
  v_mul_f32 v20, 0x3acccccd, v20
  v_fma_f32 v20, -v10, v10, v20
  v_max_f32 v20, 0, v20
  v_cvt_pk_bf16_f32 v21, v10, v10
  v_and_b32 v21, s62, v21
  v_cvt_pk_bf16_f32 v20, v20, v20
  v_and_b32 v20, s62, v20
  v_add_f32 v20, 0x3727c5ac, v20
  v_cvt_pk_bf16_f32 v20, v20, v20
  v_and_b32 v20, s62, v20
  v_sqrt_f32 v20, v20
  s_nop 0
  v_cvt_pk_bf16_f32 v20, v20, v20
  v_and_b32 v20, s62, v20
  v_rcp_f32 v24, v20
  v_sub_f32 v22, v22, v21
  v_sub_f32 v23, v23, v21
  v_cvt_pk_bf16_f32 v22, v22, v23
  v_and_b32 v23, s62, v22
  v_lshlrev_b32 v22, 16, v22
  v_mul_f32 v22, v22, v24
  v_mul_f32 v23, v23, v24
  v_cvt_pk_bf16_f32 v22, v22, v23
  ds_write_b32 v149, v22
  s_waitcnt lgkmcnt(0)
  s_barrier
  s_cmp_eq_u32 s3, 4
  s_cbranch_scc1 L_fin
  ds_read_b128 v[112:115], v150 offset:52288
  ds_read_b128 v[116:119], v150 offset:52352
  ds_read_b128 v[120:123], v150 offset:52416
  ds_read_b128 v[124:127], v150 offset:52480
  ds_read_b128 v[128:131], v150 offset:52544
  ds_read_b128 v[132:135], v150 offset:52608
  ds_read_b128 v[136:139], v150 offset:52672
  ds_read_b128 v[140:143], v150 offset:52736
  ds_read_b128 v[24:27], v150 offset:52800
  ds_read_b128 v[28:31], v150 offset:52864
  ds_read_b128 v[32:35], v150 offset:52928
  ds_read_b128 v[36:39], v150 offset:52992
  s_waitcnt lgkmcnt(11)
  v_mfma_f32_16x16x32_bf16 v[12:15], v[112:115], a[0:3], 0
  ds_read_b128 v[112:115], v150 offset:53056
  s_waitcnt lgkmcnt(11)
  v_mfma_f32_16x16x32_bf16 v[12:15], v[116:119], a[4:7], v[12:15]
  ds_read_b128 v[116:119], v150 offset:53120
  s_waitcnt lgkmcnt(11)
  v_mfma_f32_16x16x32_bf16 v[12:15], v[120:123], a[8:11], v[12:15]
  ds_read_b128 v[120:123], v150 offset:53184
  s_waitcnt lgkmcnt(11)
  v_mfma_f32_16x16x32_bf16 v[12:15], v[124:127], a[12:15], v[12:15]
  ds_read_b128 v[124:127], v150 offset:53248
  s_waitcnt lgkmcnt(11)
  v_mfma_f32_16x16x32_bf16 v[12:15], v[128:131], a[16:19], v[12:15]
  ds_read_b128 v[128:131], v150 offset:53312
  s_waitcnt lgkmcnt(11)
  v_mfma_f32_16x16x32_bf16 v[12:15], v[132:135], a[20:23], v[12:15]
  ds_read_b128 v[132:135], v150 offset:53376
  s_waitcnt lgkmcnt(11)
  v_mfma_f32_16x16x32_bf16 v[12:15], v[136:139], a[24:27], v[12:15]
  ds_read_b128 v[136:139], v150 offset:53440
  s_waitcnt lgkmcnt(11)
  v_mfma_f32_16x16x32_bf16 v[12:15], v[140:143], a[28:31], v[12:15]
  ds_read_b128 v[140:143], v150 offset:53504
  s_waitcnt lgkmcnt(11)
  v_mfma_f32_16x16x32_bf16 v[12:15], v[24:27], a[32:35], v[12:15]
  s_waitcnt lgkmcnt(10)
  v_mfma_f32_16x16x32_bf16 v[12:15], v[28:31], a[36:39], v[12:15]
  s_waitcnt lgkmcnt(9)
  v_mfma_f32_16x16x32_bf16 v[12:15], v[32:35], a[40:43], v[12:15]
  s_waitcnt lgkmcnt(8)
  v_mfma_f32_16x16x32_bf16 v[12:15], v[36:39], a[44:47], v[12:15]
  s_waitcnt lgkmcnt(7)
  v_mfma_f32_16x16x32_bf16 v[12:15], v[112:115], a[48:51], v[12:15]
  s_waitcnt lgkmcnt(6)
  v_mfma_f32_16x16x32_bf16 v[12:15], v[116:119], a[52:55], v[12:15]
  s_waitcnt lgkmcnt(5)
  v_mfma_f32_16x16x32_bf16 v[12:15], v[120:123], a[56:59], v[12:15]
  s_waitcnt lgkmcnt(4)
  v_mfma_f32_16x16x32_bf16 v[12:15], v[124:127], a[60:63], v[12:15]
  s_waitcnt lgkmcnt(3)
  v_mfma_f32_16x16x32_bf16 v[12:15], v[128:131], a[64:67], v[12:15]
  s_waitcnt lgkmcnt(2)
  v_mfma_f32_16x16x32_bf16 v[12:15], v[132:135], a[68:71], v[12:15]
  s_waitcnt lgkmcnt(1)
  v_mfma_f32_16x16x32_bf16 v[12:15], v[136:139], a[72:75], v[12:15]
  s_waitcnt lgkmcnt(0)
  v_mfma_f32_16x16x32_bf16 v[12:15], v[140:143], a[76:79], v[12:15]
  s_nop 7
  v_cmp_gt_f32 vcc, 0, v12
  s_nop 1
  v_cndmask_b32 v10, v12, v155, vcc
  v_cvt_pk_bf16_f32 v10, v10, v10
  ds_write_b16 v152, v10
  s_waitcnt lgkmcnt(0)
  s_barrier
  ds_read_b128 v[16:19], v150 offset:57600
  ds_read_b128 v[44:47], v150 offset:57664
  v_mov_b32 v42, s46
  v_mov_b32 v38, s46
  s_waitcnt lgkmcnt(1)
  v_mfma_f32_16x16x32_bf16 v[112:115], v[16:19], a[80:83], 0
  v_mfma_f32_16x16x32_bf16 v[116:119], v[16:19], a[88:91], 0
  v_mfma_f32_16x16x32_bf16 v[120:123], v[16:19], v[48:51], 0
  v_mfma_f32_16x16x32_bf16 v[124:127], v[16:19], v[56:59], 0
  v_mfma_f32_16x16x32_bf16 v[128:131], v[16:19], v[64:67], 0
  v_mfma_f32_16x16x32_bf16 v[132:135], v[16:19], v[72:75], 0
  v_mfma_f32_16x16x32_bf16 v[136:139], v[16:19], v[80:83], 0
  v_mfma_f32_16x16x32_bf16 v[140:143], v[16:19], v[88:91], 0
  v_mfma_f32_16x16x32_bf16 v[24:27], v[16:19], v[96:99], 0
  v_mfma_f32_16x16x32_bf16 v[28:31], v[16:19], v[104:107], 0
  s_waitcnt lgkmcnt(0)
  v_mfma_f32_16x16x32_bf16 v[112:115], v[44:47], a[84:87], v[112:115]
  v_mfma_f32_16x16x32_bf16 v[116:119], v[44:47], a[92:95], v[116:119]
  v_mfma_f32_16x16x32_bf16 v[120:123], v[44:47], v[52:55], v[120:123]
  v_mfma_f32_16x16x32_bf16 v[124:127], v[44:47], v[60:63], v[124:127]
  v_mfma_f32_16x16x32_bf16 v[128:131], v[44:47], v[68:71], v[128:131]
  v_mfma_f32_16x16x32_bf16 v[132:135], v[44:47], v[76:79], v[132:135]
  v_mfma_f32_16x16x32_bf16 v[136:139], v[44:47], v[84:87], v[136:139]
  v_mfma_f32_16x16x32_bf16 v[140:143], v[44:47], v[92:95], v[140:143]
  v_mfma_f32_16x16x32_bf16 v[24:27], v[44:47], v[100:103], v[24:27]
  v_mfma_f32_16x16x32_bf16 v[28:31], v[44:47], v[108:111], v[28:31]
  s_nop 0
  v_cndmask_b32 v10, v112, v120, s[56:57]
  s_nop 2
  v_cndmask_b32 v11, v128, v136, s[56:57]
  v_cndmask_b32 v40, v10, v11, s[58:59]
  v_cndmask_b32 v10, v116, v124, s[56:57]
  v_cndmask_b32 v11, v132, v140, s[56:57]
  v_cndmask_b32 v41, v10, v11, s[58:59]
  buffer_store_dwordx4 v[40:43], v156, s[12:15], s72 offen sc1
  v_mov_b32 v36, v24
  v_mov_b32 v37, v28
  s_mov_b64 exec, 0xffff
  buffer_store_dwordx4 v[36:39], v156, s[12:15], s72 offen offset:1024 sc1
  s_branch L_fin
L_E:
  v_lshrrev_b32 v22, 4, v0
  v_min_u32 v22, 1, v22
  v_and_b32 v10, 15, v0
  v_lshlrev_b32 v1, 13, v22
  v_lshl_add_u32 v1, v10, 4, v1
  s_lshl_b32 s73, s3, 8
  s_lshl_b32 s72, s96, 10
  s_add_u32 s72, s72, s73
  s_add_u32 s72, s72, 40960
  buffer_load_dwordx4 v[80:83], v1, s[12:15], s72 offen sc1
  s_and_b32 s64, s49, 127
  s_lshl_b32 s64, s64, 7
  s_mul_i32 s63, s96, 244480
  s_add_u32 s63, s63, s64
  s_mul_i32 s64, s3, 61440
  s_add_u32 s63, s63, s64
  s_add_u32 s63, s63, 1966080
  v_lshrrev_b32 v10, 3, v0
  v_mul_u32_u24 v10, 2560, v10
  v_and_b32 v11, 7, v0
  v_lshl_add_u32 v20, v11, 4, v10
  s_mov_b32 s16, s32
  s_and_b32 s17, s33, 0xffff
  s_mov_b32 s18, 7864320
  s_mov_b32 s19, 0x20000
  buffer_load_dwordx4 a[24:27], v20, s[16:19], s63 offen offset:0 nt
  buffer_load_dwordx4 a[28:31], v20, s[16:19], s63 offen offset:1280 nt
  s_add_u32 s63, s63, 20480
  buffer_load_dwordx4 a[32:35], v20, s[16:19], s63 offen offset:0 nt
  buffer_load_dwordx4 a[36:39], v20, s[16:19], s63 offen offset:1280 nt
  s_add_u32 s63, s63, 20480
  buffer_load_dwordx4 a[40:43], v20, s[16:19], s63 offen offset:0 nt
  buffer_load_dwordx4 a[44:47], v20, s[16:19], s63 offen offset:1280 nt
  s_add_u32 s63, s63, 1925120
  buffer_load_dwordx4 a[48:51], v20, s[16:19], s63 offen offset:0 nt
  buffer_load_dwordx4 a[52:55], v20, s[16:19], s63 offen offset:1280 nt
  s_add_u32 s63, s63, 20480
  buffer_load_dwordx4 a[56:59], v20, s[16:19], s63 offen offset:0 nt
  buffer_load_dwordx4 a[60:63], v20, s[16:19], s63 offen offset:1280 nt
  s_add_u32 s63, s63, 20480
  buffer_load_dwordx4 a[64:67], v20, s[16:19], s63 offen offset:0 nt
  buffer_load_dwordx4 a[68:71], v20, s[16:19], s63 offen offset:1280 nt
  s_mul_i32 s63, s3, 192
  s_add_u32 s63, s63, 49152
  v_and_b32 v10, 15, v0
  v_mul_u32_u24 v149, 12, v10
  v_add_u32 v149, s63, v149
  v_lshrrev_b32 v150, 3, v0
  v_lshlrev_b32 v150, 3, v150
  v_add_u32 v150, s63, v150
  v_and_b32 v10, 7, v0
  v_lshrrev_b32 v11, 4, v0
  v_and_b32 v20, 1, v11
  v_lshlrev_b32 v20, 4, v20
  v_lshl_add_u32 v20, v10, 5, v20
  v_lshrrev_b32 v11, 1, v11
  v_lshl_add_u32 v20, v11, 8, v20
  s_lshl_b32 s63, s3, 9
  s_add_u32 s63, s63, 52224
  v_add_u32 v20, s63, v20
  v_lshlrev_b32 v21, 4, v0
  v_add_u32 v21, 3328, v21
  v_bfe_u32 v10, v0, 3, 1
  v_cmp_eq_u32 vcc, v10, v11
  s_nop 1
  v_cndmask_b32 v148, v21, v20, vcc
  v_lshlrev_b32 v151, 3, v0
  v_lshlrev_b32 v2, 4, v0
  v_add_u32 v151, 52224, v151
  v_mul_u32_u24 v152, 768, v22
  v_add_u32 v152, v152, v149
  s_mov_b32 s75, 0
  s_waitcnt vmcnt(12)
  v_cmp_ne_u32 vcc, s46, v83
  s_cbranch_vccz L_ocE
  s_mov_b32 s78, 1000000
L_p38:
  buffer_load_dwordx4 v[80:83], v1, s[12:15], s72 offen sc1
  s_sub_u32 s78, s78, 1
  s_cbranch_scc1 L_p38_x
  s_waitcnt vmcnt(0)
  v_cmp_ne_u32 vcc, s46, v83
  s_cbranch_vccnz L_p38
L_p38_x:
  s_waitcnt vmcnt(0)
L_ocE:
  ds_write_b32 v152, v80 offset:0
  ds_write_b32 v152, v81 offset:4
  ds_write_b32 v152, v82 offset:8
  s_waitcnt lgkmcnt(0)
  ds_read_b64 v[84:85], v150 offset:0
  ds_read_b64 v[86:87], v150 offset:64
  ds_read_b64 v[88:89], v150 offset:128
  ds_read_b64 v[90:91], v150 offset:768
  ds_read_b64 v[92:93], v150 offset:832
  ds_read_b64 v[94:95], v150 offset:896
  s_waitcnt vmcnt(0) lgkmcnt(0)
  v_and_b32 v16, v84, v3
  v_and_b32 v17, v84, v4
  v_and_b32 v18, v84, v5
  v_and_b32 v19, v84, v6
  v_and_b32 v44, v85, v3
  v_and_b32 v45, v85, v4
  v_and_b32 v46, v85, v5
  v_and_b32 v47, v85, v6
  v_mfma_f32_16x16x32_bf16 v[12:15], v[16:19], a[24:27], 0
  v_and_b32 v16, v86, v3
  v_and_b32 v17, v86, v4
  v_and_b32 v18, v86, v5
  v_and_b32 v19, v86, v6
  v_mfma_f32_16x16x32_bf16 v[12:15], v[44:47], a[28:31], v[12:15]
  v_and_b32 v44, v87, v3
  v_and_b32 v45, v87, v4
  v_and_b32 v46, v87, v5
  v_and_b32 v47, v87, v6
  v_mfma_f32_16x16x32_bf16 v[12:15], v[16:19], a[32:35], v[12:15]
  v_and_b32 v16, v88, v3
  v_and_b32 v17, v88, v4
  v_and_b32 v18, v88, v5
  v_and_b32 v19, v88, v6
  v_mfma_f32_16x16x32_bf16 v[12:15], v[44:47], a[36:39], v[12:15]
  v_and_b32 v44, v89, v3
  v_and_b32 v45, v89, v4
  v_and_b32 v46, v89, v5
  v_and_b32 v47, v89, v6
  v_mfma_f32_16x16x32_bf16 v[12:15], v[16:19], a[40:43], v[12:15]
  v_and_b32 v16, v90, v3
  v_and_b32 v17, v90, v4
  v_and_b32 v18, v90, v5
  v_and_b32 v19, v90, v6
  v_mfma_f32_16x16x32_bf16 v[12:15], v[44:47], a[44:47], v[12:15]
  v_and_b32 v44, v91, v3
  v_and_b32 v45, v91, v4
  v_and_b32 v46, v91, v5
  v_and_b32 v47, v91, v6
  v_mfma_f32_16x16x32_bf16 v[12:15], v[16:19], a[48:51], v[12:15]
  v_and_b32 v16, v92, v3
  v_and_b32 v17, v92, v4
  v_and_b32 v18, v92, v5
  v_and_b32 v19, v92, v6
  v_mfma_f32_16x16x32_bf16 v[12:15], v[44:47], a[52:55], v[12:15]
  v_and_b32 v44, v93, v3
  v_and_b32 v45, v93, v4
  v_and_b32 v46, v93, v5
  v_and_b32 v47, v93, v6
  v_mfma_f32_16x16x32_bf16 v[12:15], v[16:19], a[56:59], v[12:15]
  v_and_b32 v16, v94, v3
  v_and_b32 v17, v94, v4
  v_and_b32 v18, v94, v5
  v_and_b32 v19, v94, v6
  v_mfma_f32_16x16x32_bf16 v[12:15], v[44:47], a[60:63], v[12:15]
  v_and_b32 v44, v95, v3
  v_and_b32 v45, v95, v4
  v_and_b32 v46, v95, v5
  v_and_b32 v47, v95, v6
  v_mfma_f32_16x16x32_bf16 v[12:15], v[16:19], a[64:67], v[12:15]
  s_nop 0
  v_mfma_f32_16x16x32_bf16 v[12:15], v[44:47], a[68:71], v[12:15]
  s_lshl_b32 s72, s49, 9
  s_add_u32 s72, s72, 475136
  s_branch L_Wout
L_W:
  v_lshrrev_b32 v22, 4, v0
  v_min_u32 v22, 0, v22
  v_and_b32 v10, 15, v0
  v_lshlrev_b32 v1, 13, v22
  v_lshl_add_u32 v1, v10, 4, v1
  s_lshl_b32 s73, s3, 8
  s_lshl_b32 s72, s96, 10
  s_add_u32 s72, s72, s73
  s_add_u32 s72, s72, 32768
  buffer_load_dwordx4 v[80:83], v1, s[12:15], s72 offen sc1
  s_and_b32 s64, s49, 127
  s_lshl_b32 s64, s64, 7
  s_mul_i32 s63, s96, 244480
  s_add_u32 s63, s63, s64
  s_mul_i32 s64, s3, 61440
  s_add_u32 s63, s63, s64
  v_lshrrev_b32 v10, 3, v0
  v_mul_u32_u24 v10, 2560, v10
  v_and_b32 v11, 7, v0
  v_lshl_add_u32 v20, v11, 4, v10
  s_mov_b32 s16, s32
  s_and_b32 s17, s33, 0xffff
  s_mov_b32 s18, 7864320
  s_mov_b32 s19, 0x20000
  buffer_load_dwordx4 a[0:3], v20, s[16:19], s63 offen offset:0 nt
  buffer_load_dwordx4 a[4:7], v20, s[16:19], s63 offen offset:1280 nt
  s_add_u32 s63, s63, 20480
  buffer_load_dwordx4 a[8:11], v20, s[16:19], s63 offen offset:0 nt
  buffer_load_dwordx4 a[12:15], v20, s[16:19], s63 offen offset:1280 nt
  s_add_u32 s63, s63, 20480
  buffer_load_dwordx4 a[16:19], v20, s[16:19], s63 offen offset:0 nt
  buffer_load_dwordx4 a[20:23], v20, s[16:19], s63 offen offset:1280 nt
  s_and_b32 s64, s49, 127
  s_lshl_b32 s64, s64, 7
  s_mul_i32 s63, s96, 244480
  s_add_u32 s63, s63, s64
  s_mul_i32 s64, s3, 61440
  s_add_u32 s63, s63, s64
  s_add_u32 s63, s63, 5898240
  v_lshrrev_b32 v10, 3, v0
  v_mul_u32_u24 v10, 2560, v10
  v_and_b32 v11, 7, v0
  v_lshl_add_u32 v20, v11, 4, v10
  s_mov_b32 s16, s32
  s_and_b32 s17, s33, 0xffff
  s_mov_b32 s18, 7864320
  s_mov_b32 s19, 0x20000
  buffer_load_dwordx4 a[72:75], v20, s[16:19], s63 offen offset:0 nt
  buffer_load_dwordx4 a[76:79], v20, s[16:19], s63 offen offset:1280 nt
  s_add_u32 s63, s63, 20480
  buffer_load_dwordx4 a[80:83], v20, s[16:19], s63 offen offset:0 nt
  buffer_load_dwordx4 a[84:87], v20, s[16:19], s63 offen offset:1280 nt
  s_add_u32 s63, s63, 20480
  buffer_load_dwordx4 a[88:91], v20, s[16:19], s63 offen offset:0 nt
  buffer_load_dwordx4 a[92:95], v20, s[16:19], s63 offen offset:1280 nt
  s_mul_i32 s63, s3, 192
  s_add_u32 s63, s63, 49152
  v_and_b32 v10, 15, v0
  v_mul_u32_u24 v149, 12, v10
  v_add_u32 v149, s63, v149
  v_lshrrev_b32 v150, 3, v0
  v_lshlrev_b32 v150, 3, v150
  v_add_u32 v150, s63, v150
  v_and_b32 v10, 7, v0
  v_lshrrev_b32 v11, 4, v0
  v_and_b32 v20, 1, v11
  v_lshlrev_b32 v20, 4, v20
  v_lshl_add_u32 v20, v10, 5, v20
  v_lshrrev_b32 v11, 1, v11
  v_lshl_add_u32 v20, v11, 8, v20
  s_lshl_b32 s63, s3, 9
  s_add_u32 s63, s63, 52224
  v_add_u32 v20, s63, v20
  v_lshlrev_b32 v21, 4, v0
  v_add_u32 v21, 3328, v21
  v_bfe_u32 v10, v0, 3, 1
  v_cmp_eq_u32 vcc, v10, v11
  s_nop 1
  v_cndmask_b32 v148, v21, v20, vcc
  v_lshlrev_b32 v151, 3, v0
  v_lshlrev_b32 v2, 4, v0
  v_add_u32 v151, 52224, v151
  v_mul_u32_u24 v152, 768, v22
  v_add_u32 v152, v152, v149
  s_mov_b32 s75, 0
  s_waitcnt vmcnt(12)
  v_cmp_ne_u32 vcc, s46, v83
  s_cbranch_vccz L_ocW
  s_mov_b32 s78, 1000000
L_p39:
  buffer_load_dwordx4 v[80:83], v1, s[12:15], s72 offen sc1
  s_sub_u32 s78, s78, 1
  s_cbranch_scc1 L_p39_x
  s_waitcnt vmcnt(0)
  v_cmp_ne_u32 vcc, s46, v83
  s_cbranch_vccnz L_p39
L_p39_x:
  s_waitcnt vmcnt(0)
L_ocW:
  ds_write_b32 v152, v80 offset:0
  ds_write_b32 v152, v81 offset:4
  ds_write_b32 v152, v82 offset:8
  s_waitcnt lgkmcnt(0)
  ds_read_b64 v[84:85], v150 offset:0
  ds_read_b64 v[86:87], v150 offset:64
  ds_read_b64 v[88:89], v150 offset:128
  s_waitcnt vmcnt(6) lgkmcnt(0)
  v_and_b32 v16, v84, v3
  v_and_b32 v17, v84, v4
  v_and_b32 v18, v84, v5
  v_and_b32 v19, v84, v6
  v_and_b32 v44, v85, v3
  v_and_b32 v45, v85, v4
  v_and_b32 v46, v85, v5
  v_and_b32 v47, v85, v6
  v_mfma_f32_16x16x32_bf16 v[12:15], v[16:19], a[0:3], 0
  v_and_b32 v16, v86, v3
  v_and_b32 v17, v86, v4
  v_and_b32 v18, v86, v5
  v_and_b32 v19, v86, v6
  v_mfma_f32_16x16x32_bf16 v[12:15], v[44:47], a[4:7], v[12:15]
  v_and_b32 v44, v87, v3
  v_and_b32 v45, v87, v4
  v_and_b32 v46, v87, v5
  v_and_b32 v47, v87, v6
  v_mfma_f32_16x16x32_bf16 v[12:15], v[16:19], a[8:11], v[12:15]
  v_and_b32 v16, v88, v3
  v_and_b32 v17, v88, v4
  v_and_b32 v18, v88, v5
  v_and_b32 v19, v88, v6
  v_mfma_f32_16x16x32_bf16 v[12:15], v[44:47], a[12:15], v[12:15]
  v_and_b32 v44, v89, v3
  v_and_b32 v45, v89, v4
  v_and_b32 v46, v89, v5
  v_and_b32 v47, v89, v6
  v_mfma_f32_16x16x32_bf16 v[12:15], v[16:19], a[16:19], v[12:15]
  s_nop 0
  v_mfma_f32_16x16x32_bf16 v[12:15], v[44:47], a[20:23], v[12:15]
  s_add_u32 s63, s96, 24
  s_lshl_b32 s64, s63, 15
  s_add_u32 s64, s64, 1048576
  s_lshl_b32 s73, s3, 8
  s_add_u32 s64, s64, s73
  s_add_u32 s65, s64, 4096
  s_add_u32 s66, s64, 8192
  s_add_u32 s67, s64, 12288
  s_add_u32 s68, s64, 16384
  s_add_u32 s69, s64, 20480
  s_add_u32 s70, s64, 24576
  s_add_u32 s71, s64, 28672
  v_lshrrev_b32 v153, 4, v0
  v_lshlrev_b32 v153, 10, v153
  v_and_b32 v10, 15, v0
  v_lshl_add_u32 v153, v10, 4, v153
  s_lshl_b32 s72, s49, 9
  s_add_u32 s72, s72, 360448
  s_mov_b32 s78, 1000000
L_p40:
  buffer_load_dwordx4 v[48:51], v153, s[12:15], s64 offen sc1
  buffer_load_dwordx4 v[52:55], v153, s[12:15], s65 offen sc1
  buffer_load_dwordx4 v[56:59], v153, s[12:15], s66 offen sc1
  buffer_load_dwordx4 v[60:63], v153, s[12:15], s67 offen sc1
  buffer_load_dwordx4 v[64:67], v153, s[12:15], s68 offen sc1
  buffer_load_dwordx4 v[68:71], v153, s[12:15], s69 offen sc1
  buffer_load_dwordx4 v[72:75], v153, s[12:15], s70 offen sc1
  buffer_load_dwordx4 v[76:79], v153, s[12:15], s71 offen sc1
  s_sub_u32 s78, s78, 1
  s_cbranch_scc1 L_p40_x
  s_waitcnt vmcnt(0)
  v_min_u32 v10, v51, v79
  v_max_u32 v11, v51, v79
  v_min3_u32 v10, v10, v55, v59
  v_max3_u32 v11, v11, v55, v59
  v_min3_u32 v10, v10, v63, v67
  v_max3_u32 v11, v11, v63, v67
  v_min3_u32 v10, v10, v71, v75
  v_max3_u32 v11, v11, v71, v75
  v_cmp_ne_u32 vcc, s46, v10
  v_cmp_ne_u32 s[80:81], s46, v11
  s_nop 0
  s_or_b64 vcc, vcc, s[80:81]
  s_cbranch_vccnz L_p40
L_p40_x:
  s_waitcnt vmcnt(0)
  v_pk_add_f32 v[48:49], v[48:49], v[52:53]
  v_add_f32 v50, v50, v54
  v_pk_add_f32 v[56:57], v[56:57], v[60:61]
  v_add_f32 v58, v58, v62
  v_pk_add_f32 v[64:65], v[64:65], v[68:69]
  v_add_f32 v66, v66, v70
  v_pk_add_f32 v[72:73], v[72:73], v[76:77]
  v_add_f32 v74, v74, v78
  v_pk_add_f32 v[48:49], v[48:49], v[56:57]
  v_add_f32 v50, v50, v58
  v_pk_add_f32 v[64:65], v[64:65], v[72:73]
  v_add_f32 v66, v66, v74
  v_pk_add_f32 v[20:21], v[48:49], v[64:65]
  v_add_f32 v22, v50, v66
  v_mov_b32 v48, v20
  v_mov_b32 v49, v21
  v_mov_b32 v50, v22
  v_permlane16_swap_b32 v20, v48
  v_permlane16_swap_b32 v21, v49
  v_permlane16_swap_b32 v22, v50
  v_add_f32 v20, v20, v48
  v_add_f32 v21, v21, v49
  v_add_f32 v22, v22, v50
  v_mov_b32 v48, v20
  v_mov_b32 v49, v21
  v_mov_b32 v50, v22
  v_permlane32_swap_b32 v20, v48
  v_permlane32_swap_b32 v21, v49
  v_permlane32_swap_b32 v22, v50
  v_add_f32 v20, v20, v48
  v_add_f32 v21, v21, v49
  v_add_f32 v22, v22, v50
  v_cvt_pk_bf16_f32 v20, v20, v20
  v_cvt_pk_bf16_f32 v21, v21, v21
  v_cvt_pk_bf16_f32 v22, v22, v22
  ds_write_b32 v149, v20 offset:0
  ds_write_b32 v149, v21 offset:4
  ds_write_b32 v149, v22 offset:8
  s_waitcnt lgkmcnt(0)
  ds_read_b64 v[84:85], v150 offset:0
  ds_read_b64 v[86:87], v150 offset:64
  ds_read_b64 v[88:89], v150 offset:128
  s_waitcnt lgkmcnt(2)
  v_and_b32 v16, v84, v3
  v_and_b32 v17, v84, v4
  v_and_b32 v18, v84, v5
  v_and_b32 v19, v84, v6
  v_and_b32 v44, v85, v3
  v_and_b32 v45, v85, v4
  v_and_b32 v46, v85, v5
  v_and_b32 v47, v85, v6
  v_mfma_f32_16x16x32_bf16 v[12:15], v[16:19], a[72:75], v[12:15]
  s_waitcnt lgkmcnt(1)
  v_and_b32 v16, v86, v3
  v_and_b32 v17, v86, v4
  v_and_b32 v18, v86, v5
  v_and_b32 v19, v86, v6
  v_mfma_f32_16x16x32_bf16 v[12:15], v[44:47], a[76:79], v[12:15]
  v_and_b32 v44, v87, v3
  v_and_b32 v45, v87, v4
  v_and_b32 v46, v87, v5
  v_and_b32 v47, v87, v6
  v_mfma_f32_16x16x32_bf16 v[12:15], v[16:19], a[80:83], v[12:15]
  s_waitcnt lgkmcnt(0)
  v_and_b32 v16, v88, v3
  v_and_b32 v17, v88, v4
  v_and_b32 v18, v88, v5
  v_and_b32 v19, v88, v6
  v_mfma_f32_16x16x32_bf16 v[12:15], v[44:47], a[84:87], v[12:15]
  v_and_b32 v44, v89, v3
  v_and_b32 v45, v89, v4
  v_and_b32 v46, v89, v5
  v_and_b32 v47, v89, v6
  v_mfma_f32_16x16x32_bf16 v[12:15], v[16:19], a[88:91], v[12:15]
  s_nop 0
  v_mfma_f32_16x16x32_bf16 v[12:15], v[44:47], a[92:95], v[12:15]
L_Wout:
  s_nop 7
  ds_write_b128 v148, v[12:15]
  s_waitcnt lgkmcnt(0)
  s_barrier
  s_cmp_lg_u32 s3, 0
  s_cbranch_scc1 L_end
  s_mov_b32 exec_hi, 0
  ds_read2_b64 v[24:27], v151 offset0:0 offset1:32
  ds_read2_b64 v[28:31], v151 offset0:64 offset1:96
  ds_read2_b64 v[32:35], v151 offset0:128 offset1:160
  ds_read2_b64 v[36:39], v151 offset0:192 offset1:224
  v_mov_b32 v42, s46
  s_waitcnt lgkmcnt(3)
  v_pk_add_f32 v[24:25], v[24:25], v[26:27]
  s_waitcnt lgkmcnt(2)
  v_pk_add_f32 v[28:29], v[28:29], v[30:31]
  s_waitcnt lgkmcnt(1)
  v_pk_add_f32 v[32:33], v[32:33], v[34:35]
  s_waitcnt lgkmcnt(0)
  v_pk_add_f32 v[36:37], v[36:37], v[38:39]
  v_pk_add_f32 v[24:25], v[24:25], v[28:29]
  v_pk_add_f32 v[32:33], v[32:33], v[36:37]
  v_pk_add_f32 v[40:41], v[24:25], v[32:33]
  buffer_store_dwordx4 v[40:43], v2, s[12:15], s72 offen sc1
  s_branch L_fin
L_R:
  s_sub_u32 s63, s49, 104
  s_mul_i32 s63, s63, 5
  s_add_u32 s73, s63, s3
  s_lshl_b32 s63, s73, 8
  s_add_u32 s64, s63, 409600
  s_add_u32 s65, s63, 430080
  s_add_u32 s66, s63, 450560
  s_add_u32 s67, s63, 471040
  s_add_u32 s68, s63, 491520
  s_add_u32 s69, s63, 512000
  s_add_u32 s70, s63, 401408
  s_lshl_b32 s71, s73, 6
  v_and_b32 v2, 15, v0
  v_lshrrev_b32 v1, 4, v0
  v_mul_u32_u24 v1, 5120, v1
  v_lshlrev_b32 v20, 2, v2
  v_lshlrev_b32 v2, 4, v2
  v_add_u32 v1, v1, v2
  s_mov_b32 s20, s40
  s_and_b32 s21, s41, 0xffff
  s_mov_b32 s22, 1280
  s_mov_b32 s23, 0x20000
  v_lshrrev_b32 v2, 5, v2
  v_lshlrev_b32 v2, 4, v2
  v_lshrrev_b32 v20, 1, v20
  v_and_b32 v23, 1, v0
  v_lshlrev_b32 v23, 4, v23
  s_mov_b32 s78, 1000000
L_p41:
  buffer_load_dwordx4 v[72:75], v2, s[12:15], s70 offen sc1
  buffer_load_dwordx4 v[76:79], v2, s[12:15], s70 offen offset:128 sc1
  buffer_load_dwordx4 v[48:51], v1, s[12:15], s64 offen sc1
  buffer_load_dwordx4 v[52:55], v1, s[12:15], s65 offen sc1
  buffer_load_dwordx4 v[56:59], v1, s[12:15], s66 offen sc1
  buffer_load_dwordx4 v[60:63], v1, s[12:15], s67 offen sc1
  buffer_load_dwordx4 v[64:67], v1, s[12:15], s68 offen sc1
  buffer_load_dwordx4 v[68:71], v1, s[12:15], s69 offen sc1
  s_sub_u32 s78, s78, 1
  s_cbranch_scc1 L_p41_x
  s_waitcnt vmcnt(0)
  v_min_u32 v10, v74, v70
  v_max_u32 v11, v74, v70
  v_min3_u32 v10, v10, v78, v50
  v_max3_u32 v11, v11, v78, v50
  v_min3_u32 v10, v10, v54, v58
  v_max3_u32 v11, v11, v54, v58
  v_min3_u32 v10, v10, v62, v66
  v_max3_u32 v11, v11, v62, v66
  v_cmp_ne_u32 vcc, s46, v10
  v_cmp_ne_u32 s[80:81], s46, v11
  s_nop 0
  s_or_b64 vcc, vcc, s[80:81]
  s_cbranch_vccnz L_p41
L_p41_x:
  s_waitcnt vmcnt(0)
  v_pk_add_f32 v[48:49], v[48:49], v[52:53]
  v_pk_add_f32 v[56:57], v[56:57], v[60:61]
  v_pk_add_f32 v[64:65], v[64:65], v[68:69]
  v_lshrrev_b32 v24, v23, v72
  v_lshrrev_b32 v25, v23, v76
  v_lshlrev_b32 v24, 16, v24
  v_lshlrev_b32 v25, 16, v25
  v_pk_add_f32 v[10:11], v[48:49], v[56:57]
  v_pk_add_f32 v[10:11], v[10:11], v[64:65]
  v_mov_b32 v21, v10
  v_mov_b32 v22, v11
  s_nop 0
  v_permlane16_swap_b32 v10, v21
  v_permlane16_swap_b32 v11, v22
  v_add_f32 v10, v10, v21
  v_add_f32 v11, v11, v22
  v_mov_b32 v21, v10
  v_mov_b32 v22, v11
  s_nop 0
  v_permlane32_swap_b32 v10, v21
  v_permlane32_swap_b32 v11, v22
  v_add_f32 v10, v10, v21
  v_add_f32 v11, v11, v22
  v_cvt_pk_bf16_f32 v10, v10, v11
  v_and_b32 v11, s62, v10
  v_lshlrev_b32 v10, 16, v10
  v_add_f32 v10, v10, v24
  v_add_f32 v11, v11, v25
  v_cvt_pk_bf16_f32 v10, v10, v11
  s_mov_b64 exec, 0xffff
  buffer_store_short v10, v20, s[20:23], s71 offen
  buffer_store_short_d16_hi v10, v20, s[20:23], s71 offen offset:32
  s_cmp_lg_u32 s73, 0
  s_cbranch_scc1 L_fin
  s_mov_b64 exec, 1
  v_mov_b32 v11, s46
  buffer_store_dword v11, v20, s[12:15], 0 offen
L_fin:
L_end:
  s_endpgm
.section .rodata,"a"
.p2align 6
.amdhsa_kernel sequential_preLN__mha_block_cached__dense_activation_relu__decode_kernel
  .amdhsa_next_free_vgpr 256
  .amdhsa_next_free_sgpr 100
  .amdhsa_accum_offset 160
  .amdhsa_group_segment_fixed_size 0
  .amdhsa_kernarg_size 88
  .amdhsa_user_sgpr_count 2
  .amdhsa_user_sgpr_kernarg_segment_ptr 1
  .amdhsa_system_sgpr_workgroup_id_x 1
  .amdhsa_float_denorm_mode_32 3
.end_amdhsa_kernel
```
